```python
import torch

def _softmax(x, axis=-1):
    return torch.softmax(x, dim=axis)
def _gelu(x):
    return torch.nn.functional.gelu(x, approximate="tanh")
def _silu(x):
    return torch.nn.functional.silu(x)
def _sigmoid(x):
    return torch.sigmoid(x)
def _layernorm(x, axis=-1, eps=1e-5):
    m = x.mean(dim=axis, keepdim=True)
    v = x.var(dim=axis, keepdim=True, unbiased=False)
    return (x - m) / torch.sqrt(v + eps)
def _scatter_add(tgt, idx, src, axis=0):
    return tgt.clone().index_add_(axis, idx, src)
def _segment_sum(src, seg, n):
    out = torch.zeros((n,) + src.shape[1:], dtype=src.dtype)
    return out.index_add_(0, seg, src)
def _pad(x, pw):
    flat = tuple(v for pair in reversed(pw) for v in pair)
    return torch.nn.functional.pad(x, flat)

kernel_name = 'recurrent_scan__gqa_block_cached__dense_activation_silu__decode'

def setup_inputs():

    _w = (lambda a: (lambda t: t.to(torch.bfloat16) if t.is_floating_point() else t)(torch.as_tensor(a)))
    def _A_setup():
        B, Sq, D = 1, 1, 512
        Hq, Hkv, Sk, Dh = 32, 32, 8192, 128
        assert Hq % Hkv == 0, (Hq, Hkv)
        return {
            "x": _w((lambda *s: torch.randn(*s, dtype=torch.bfloat16) * 0.05)(B, Sq, D)),
            "k_cache": _w((lambda *s: torch.randn(*s, dtype=torch.bfloat16) * 3.2)(B, Hkv, Sk, Dh)),
            "v_cache": _w((lambda *s: torch.randn(*s, dtype=torch.bfloat16) * 3.2)(B, Hkv, Sk, Dh)),
            "wq": _w((lambda *s: torch.randn(*s, dtype=torch.bfloat16) * 3.2)(D, Hq * Dh) * (D ** -0.5)),
            "wo": _w((lambda *s: torch.randn(*s, dtype=torch.bfloat16) * 3.2)(Hq * Dh, D) * ((Hq * Dh) ** -0.5)),
        }
    _A_in = _A_setup()

    def _B_setup():
        B, S, D, F = 1, 1, 512, 1376
        return {
            "x": _w((lambda *s: torch.randn(*s, dtype=torch.bfloat16) * 0.05)(B, S, D)),
            "w1": _w((lambda *s: torch.randn(*s, dtype=torch.bfloat16) * 3.2)(D, F) * (D ** -0.5)),
            "w2": _w((lambda *s: torch.randn(*s, dtype=torch.bfloat16) * 0.4)(F, D) * (F ** -0.5)),
        }
    _B_in = _B_setup()

    return {
        "A_x": _A_in["x"],
        "A_k_cache": _A_in["k_cache"],
        "A_v_cache": _A_in["v_cache"],
        "A_wq": _A_in["wq"],
        "A_wo": _A_in["wo"],
        "B_x": _B_in["x"],
        "B_w1": _B_in["w1"],
        "B_w2": _B_in["w2"],
    }

def reference(A_x, A_k_cache, A_v_cache, A_wq, A_wo, B_x, B_w1, B_w2):
    def _A_ref(x, k_cache, v_cache, wq, wo):
        B, Sq, D = x.shape
        Hq, Dh = 32, 128
        Hkv = k_cache.shape[1]
        rep = Hq // Hkv
        q = (lambda x, *d: x.permute(*d))((x @ wq).reshape(B, Sq, Hq, Dh), 0, 2, 1, 3)
        k = (lambda x, n, axis: torch.repeat_interleave(x, n, dim=axis))(k_cache, rep, axis=1)
        v = (lambda x, n, axis: torch.repeat_interleave(x, n, dim=axis))(v_cache, rep, axis=1)
        scores = torch.einsum("bhqd,bhkd->bhqk", q, k) * (Dh ** -0.5)
        p = _softmax(scores, axis=-1)
        o = torch.einsum("bhqk,bhkd->bhqd", p, v)
        return (lambda x, *d: x.permute(*d))(o, 0, 2, 1, 3).reshape(B, Sq, Hq * Dh) @ wo

    def _B_ref(x, w1, w2):
        h = torch.einsum("bsd,df->bsf", x, w1)
        h = _silu(h)
        out = torch.einsum("bsf,fd->bsd", h, w2)
        return out

    x = A_x
    xn = _layernorm(x, axis=-1)
    s = _A_ref(xn, A_k_cache, A_v_cache, A_wq, A_wo)
    g = _silu(_B_ref(xn, B_w1, B_w2))
    return x + s * g
```

```asm
; @launch grid=(256,1,1) block=(512,1,1) lds=147456
.amdgcn_target "amdgcn-amd-amdhsa--gfx950"
.text
.globl recurrent_scan__gqa_block_cached__dense_activation_silu__decode_kernel
.p2align 8
.type recurrent_scan__gqa_block_cached__dense_activation_silu__decode_kernel,@function
recurrent_scan__gqa_block_cached__dense_activation_silu__decode_kernel:
    s_getpc_b64 s[76:77]
L_pc:
    s_mov_b32 s78, L_code_end-L_pc
    s_mov_b32 s79, 0x20000
    v_lshlrev_b32 v7, 7, v0
    s_mov_b32 m0, 12288
    s_load_dwordx16 s[4:19], s[0:1], 0
    buffer_load_dword v7, s[76:79], 0 offen lds
    s_load_dwordx4 s[20:23], s[0:1], 64
    s_load_dwordx2 s[24:25], s[0:1], 80
    s_cmp_ge_u32 s2, 256
    s_cbranch_scc1 L_exit
    v_and_b32 v1, 63, v0
    v_lshrrev_b32 v6, 6, v0
    s_nop 0
    v_readfirstlane_b32 s26, v6
    s_and_b32 s27, s2, 31
    s_lshr_b32 s3, s2, 5
    v_lshrrev_b32 v44, 4, v1
    v_and_b32 v45, 15, v1
    v_lshrrev_b32 v40, 2, v45
    v_lshlrev_b32 v40, 8, v40
    v_lshl_add_u32 v40, v44, 6, v40
    v_and_b32 v41, 3, v45
    v_lshl_add_u32 v40, v41, 4, v40
    v_lshl_add_u32 v2, v6, 12, v40
    v_lshrrev_b32 v42, 1, v45
    v_and_b32 v43, 1, v45
    v_lshrrev_b32 v40, 1, v6
    v_lshlrev_b32 v40, 4, v40
    v_lshl_add_u32 v40, v44, 1, v40
    v_add_u32 v40, v40, v43
    v_lshlrev_b32 v40, 13, v40
    v_and_b32 v41, 1, v6
    v_lshl_add_u32 v40, v41, 7, v40
    v_lshl_add_u32 v4, v42, 4, v40
    v_lshlrev_b32 v7, 4, v1
    s_lshl_b32 s80, s27, 21
    s_lshl_b32 s81, s3, 18
    s_add_u32 s80, s80, s81
    s_lshl_b32 s81, s27, 8
    s_lshl_b32 s97, s3, 19
    s_add_u32 s81, s81, s97
    s_lshl_b32 s96, s27, 3
    s_add_u32 s96, s96, s3
    s_waitcnt lgkmcnt(0)
    s_add_u32 s28, s6, s80
    s_addc_u32 s29, s7, 0
    s_mov_b32 s30, 262144
    s_mov_b32 s31, 0x20000
    s_mov_b32 s52, s4
    s_mov_b32 s53, s5
    s_mov_b32 s54, 1024
    s_mov_b32 s55, 0x20000
    s_add_u32 s36, s10, s81
    s_addc_u32 s37, s11, 0
    s_mov_b32 s38, 516352
    s_mov_b32 s39, 0x20000
    s_add_u32 s32, s8, s80
    s_addc_u32 s33, s9, 0
    s_mov_b32 s34, 262144
    s_mov_b32 s35, 0x20000
    s_lshl_b32 s80, s96, 11
    s_add_u32 s56, s24, s80
    s_addc_u32 s57, s25, 0
    s_mov_b32 s58, 2048
    s_mov_b32 s59, 0x20000
    s_bfe_u32 s80, s2, 0x20001
    s_lshr_b32 s81, s2, 3
    s_lshl_b32 s82, s80, 5
    s_add_u32 s82, s82, s81
    s_mul_i32 s97, s80, 12
    s_add_u32 s97, s97, s81
    s_add_u32 s97, s97, 128
    s_cmp_lt_u32 s81, 12
    s_cselect_b32 s97, s97, 255
    s_bitcmp1_b32 s2, 0
    s_cselect_b32 s82, s97, s82
    s_mul_i32 s80, s82, 2979
    s_lshr_b32 s80, s80, 16
    s_mul_i32 s81, s80, 22
    s_sub_u32 s81, s82, s81
    s_cmp_lt_u32 s82, 176
    s_cselect_b32 s101, 1, 0
    s_lshl_b32 s82, s81, 3
    s_add_u32 s82, s82, s80
    s_mul_i32 s82, s82, s101
    s_mul_i32 s97, s80, 176128
    s_lshl_b32 s81, s81, 7
    s_add_u32 s97, s97, s81
    s_mul_i32 s97, s97, s101
    s_add_u32 s44, s16, s97
    s_addc_u32 s45, s17, 0
    s_mov_b32 s46, 0
    s_mov_b32 s47, 0x20000
    s_sub_u32 s46, 1409024, s97
    s_mul_i32 s46, s46, s101
    s_lshl_b32 s80, s82, 12
    s_add_u32 s80, s80, 0x100000
    s_add_u32 s60, s24, s80
    s_addc_u32 s61, s25, 0
    s_mov_b32 s62, 0
    s_mov_b32 s63, 0x20000
    s_mul_i32 s62, s101, 2304
    s_cmp_lg_u32 s26, 1
    s_cbranch_scc1 L_ldx_skip
    buffer_load_dwordx4 v[60:63], v7, s[52:55], 0 offen
L_ldx_skip:
    buffer_load_dwordx4 v[248:251], v4, s[36:39], 0 offen nt
    s_mov_b32 s80, 65536
    buffer_load_dwordx4 v[252:255], v4, s[36:39], s80 offen nt
    v_lshlrev_b32 v40, 3, v6
    v_lshl_add_u32 v40, v44, 1, v40
    v_add_u32 v40, v40, v43
    v_mul_u32_u24 v40, 2752, v40
    v_lshl_add_u32 v40, v42, 4, v40
    buffer_load_dwordx4 v[244:247], v40, s[44:47], 0 offen nt
    s_cmp_lg_u32 s26, 0
    s_cbranch_scc1 L_clr_skip
    v_mov_b32 v60, -1
    v_mov_b32 v61, -1
    v_mov_b32 v62, -1
    v_mov_b32 v63, -1
    buffer_store_dwordx4 v[60:63], v7, s[56:59], 0 offen sc1
    buffer_store_dwordx4 v[60:63], v7, s[56:59], 0 offen offset:1024 sc1
    buffer_store_dwordx4 v[60:63], v7, s[60:63], 0 offen sc1
    buffer_store_dwordx4 v[60:63], v7, s[60:63], 0 offen offset:1024 sc1
    buffer_store_dwordx4 v[60:63], v7, s[60:63], 0 offen offset:2048 sc1
    s_nop 1
L_clr_skip:
    s_mov_b32 s80, 0
    buffer_load_dwordx4 v[64:67], v2, s[28:31], s80 offen offset:0 nt
    s_mov_b32 s80, 0
    buffer_load_dwordx4 v[68:71], v2, s[28:31], s80 offen offset:1024 nt
    s_mov_b32 s80, 0
    buffer_load_dwordx4 v[72:75], v2, s[28:31], s80 offen offset:2048 nt
    s_mov_b32 s80, 0
    buffer_load_dwordx4 v[76:79], v2, s[28:31], s80 offen offset:3072 nt
    s_lshl_b32 s80, s82, 13
    s_add_u32 s48, s18, s80
    s_addc_u32 s49, s19, 0
    s_mov_b32 s50, 0
    s_mov_b32 s51, 0x20000
    s_cmp_lt_u32 s82, 172
    s_cselect_b32 s81, 8192, 0
    s_mul_i32 s50, s81, s101
    s_lshl_b32 s80, s27, 17
    s_lshl_b32 s81, s3, 7
    s_add_u32 s80, s80, s81
    s_add_u32 s40, s12, s80
    s_addc_u32 s41, s13, 0
    s_mov_b32 s42, 130176
    s_mov_b32 s43, 0x20000
    s_lshl_b32 s80, s27, 14
    s_add_u32 s64, s24, s80
    s_addc_u32 s65, s25, 0
    s_mov_b32 s66, 16384
    s_mov_b32 s67, 0x20000
    s_mov_b32 s68, s22
    s_mov_b32 s69, s23
    s_mov_b32 s70, 256
    s_mov_b32 s71, 0x20000
    s_and_b32 s0, s2, 7
    s_cmp_eq_u32 s0, 2
    s_cselect_b32 s83, 1, 0
    s_lshr_b32 s0, s2, 3
    v_lshlrev_b32 v40, 4, v1
    v_lshl_add_u32 v3, v6, 12, v40
    v_lshlrev_b32 v40, 4, v43
    v_mov_b32 v41, 0xffff
    v_lshlrev_b32 v40, v40, v41
    v_cmp_eq_u32 vcc, 0, v42
    s_nop 1
    v_cndmask_b32 v8, 0, v40, vcc
    v_cmp_eq_u32 vcc, 1, v42
    s_nop 1
    v_cndmask_b32 v9, 0, v40, vcc
    v_cmp_eq_u32 vcc, 2, v42
    s_nop 1
    v_cndmask_b32 v10, 0, v40, vcc
    v_cmp_eq_u32 vcc, 3, v42
    s_nop 1
    v_cndmask_b32 v11, 0, v40, vcc
    v_lshrrev_b32 v40, 3, v45
    v_mul_u32_u24 v40, 0x0202, v40
    v_add_u32 v40, 0x0100, v40
    v_or_b32 v41, 0x0c0c0000, v40
    v_lshlrev_b32 v40, 16, v40
    v_or_b32 v40, 0x0c0c, v40
    v_cmp_eq_u32 vcc, 1, v43
    s_nop 1
    v_cndmask_b32 v40, v41, v40, vcc
    v_bfe_u32 v41, v45, 1, 2
    v_mov_b32 v7, 0x0c0c0c0c
    v_cmp_eq_u32 vcc, 0, v41
    s_nop 1
    v_cndmask_b32 v12, v7, v40, vcc
    v_cmp_eq_u32 vcc, 1, v41
    s_nop 1
    v_cndmask_b32 v13, v7, v40, vcc
    v_cmp_eq_u32 vcc, 2, v41
    s_nop 1
    v_cndmask_b32 v14, v7, v40, vcc
    v_cmp_eq_u32 vcc, 3, v41
    s_nop 1
    v_cndmask_b32 v15, v7, v40, vcc
    v_lshl_add_u32 v40, v44, 3, v45
    v_lshlrev_b32 v40, 3, v40
    v_lshl_add_u32 v40, v6, 8, v40
    v_cmp_gt_u32 vcc, 8, v45
    v_mov_b32 v41, 0x10000
    s_nop 0
    v_cndmask_b32 v5, v41, v40, vcc
    v_lshlrev_b32 v40, 4, v6
    v_lshl_add_u32 v40, v44, 1, v40
    v_add_u32 v40, v40, v43
    v_lshlrev_b32 v40, 10, v40
    v_lshl_add_u32 v4, v42, 4, v40
    s_mov_b32 s84, 0xf000f
    s_mov_b32 s85, 0xf000f
    s_mov_b32 s86, 0xf000f0
    s_mov_b32 s87, 0xf000f0
    s_mov_b32 s88, 0xf000f00
    s_mov_b32 s89, 0xf000f00
    s_mov_b32 s90, 0xf000f000
    s_mov_b32 s91, 0xf000f000
    s_lshl_b32 s95, s26, 14
    s_add_u32 s95, s95, 16384
    s_mov_b32 s80, 32768
    buffer_load_dwordx4 v[80:83], v2, s[28:31], s80 offen offset:0 nt
    s_waitcnt vmcnt(7)
    s_cmp_lg_u32 s26, 1
    s_cbranch_scc1 L_ln_skip
    v_lshlrev_b32 v32, 16, v60
    v_and_b32 v33, 0xffff0000, v60
    v_lshlrev_b32 v34, 16, v61
    v_and_b32 v35, 0xffff0000, v61
    v_lshlrev_b32 v36, 16, v62
    v_and_b32 v37, 0xffff0000, v62
    v_lshlrev_b32 v38, 16, v63
    v_and_b32 v39, 0xffff0000, v63
    v_add_f32 v40, v32, v33
    v_add_f32 v41, v34, v35
    v_add_f32 v42, v36, v37
    v_add_f32 v43, v38, v39
    v_add_f32 v40, v40, v41
    v_add_f32 v42, v42, v43
    v_add_f32 v40, v40, v42
    s_nop 1
    v_add_f32_dpp v40, v40, v40 row_ror:8 row_mask:0xf bank_mask:0xf
    s_nop 1
    v_add_f32_dpp v40, v40, v40 row_ror:4 row_mask:0xf bank_mask:0xf
    s_nop 1
    v_add_f32_dpp v40, v40, v40 row_ror:2 row_mask:0xf bank_mask:0xf
    s_nop 1
    v_add_f32_dpp v40, v40, v40 row_ror:1 row_mask:0xf bank_mask:0xf
    s_nop 1
    v_add_f32_dpp v40, v40, v40 row_bcast:15 row_mask:0xa bank_mask:0xf
    s_nop 1
    v_add_f32_dpp v40, v40, v40 row_bcast:31 row_mask:0xc bank_mask:0xf
    s_nop 0
    v_readlane_b32 s81, v40, 63
    s_nop 1
    v_mov_b32 v44, s81
    v_mul_f32 v44, 0x3b000000, v44
    v_sub_f32 v41, v32, v44
    v_mul_f32 v40, v41, v41
    v_sub_f32 v42, v33, v44
    v_fmac_f32 v40, v42, v42
    v_sub_f32 v41, v34, v44
    v_fmac_f32 v40, v41, v41
    v_sub_f32 v42, v35, v44
    v_fmac_f32 v40, v42, v42
    v_sub_f32 v41, v36, v44
    v_fmac_f32 v40, v41, v41
    v_sub_f32 v42, v37, v44
    v_fmac_f32 v40, v42, v42
    v_sub_f32 v41, v38, v44
    v_fmac_f32 v40, v41, v41
    v_sub_f32 v42, v39, v44
    v_fmac_f32 v40, v42, v42
    s_nop 1
    v_add_f32_dpp v40, v40, v40 row_ror:8 row_mask:0xf bank_mask:0xf
    s_nop 1
    v_add_f32_dpp v40, v40, v40 row_ror:4 row_mask:0xf bank_mask:0xf
    s_nop 1
    v_add_f32_dpp v40, v40, v40 row_ror:2 row_mask:0xf bank_mask:0xf
    s_nop 1
    v_add_f32_dpp v40, v40, v40 row_ror:1 row_mask:0xf bank_mask:0xf
    s_nop 1
    v_add_f32_dpp v40, v40, v40 row_bcast:15 row_mask:0xa bank_mask:0xf
    s_nop 1
    v_add_f32_dpp v40, v40, v40 row_bcast:31 row_mask:0xc bank_mask:0xf
    s_nop 0
    v_readlane_b32 s81, v40, 63
    s_nop 1
    v_mov_b32 v45, s81
    v_mul_f32 v45, 0x3b000000, v45
    v_cvt_pk_bf16_f32 v45, v45, v45
    v_and_b32 v45, 0xffff0000, v45
    v_add_f32 v45, 0x3727c5ac, v45
    v_cvt_pk_bf16_f32 v45, v45, v45
    v_and_b32 v45, 0xffff0000, v45
    v_sqrt_f32 v46, v45
    s_nop 0
    v_cvt_pk_bf16_f32 v46, v46, v46
    v_and_b32 v46, 0xffff0000, v46
    v_rcp_f32 v47, v46
    v_cvt_pk_bf16_f32 v44, v44, v44
    v_and_b32 v44, 0xffff0000, v44
    v_sub_f32 v32, v32, v44
    v_sub_f32 v33, v33, v44
    v_cvt_pk_bf16_f32 v40, v32, v33
    v_lshlrev_b32 v32, 16, v40
    v_and_b32 v33, 0xffff0000, v40
    v_sub_f32 v34, v34, v44
    v_sub_f32 v35, v35, v44
    v_cvt_pk_bf16_f32 v40, v34, v35
    v_lshlrev_b32 v34, 16, v40
    v_and_b32 v35, 0xffff0000, v40
    v_sub_f32 v36, v36, v44
    v_sub_f32 v37, v37, v44
    v_cvt_pk_bf16_f32 v40, v36, v37
    v_lshlrev_b32 v36, 16, v40
    v_and_b32 v37, 0xffff0000, v40
    v_sub_f32 v38, v38, v44
    v_sub_f32 v39, v39, v44
    v_cvt_pk_bf16_f32 v40, v38, v39
    v_lshlrev_b32 v38, 16, v40
    v_and_b32 v39, 0xffff0000, v40
    v_mul_f32 v48, v32, v47
    v_fma_f32 v49, -v48, v46, v32
    v_fma_f32 v32, v49, v47, v48
    v_mul_f32 v50, v33, v47
    v_fma_f32 v51, -v50, v46, v33
    v_fma_f32 v33, v51, v47, v50
    v_mul_f32 v48, v34, v47
    v_fma_f32 v49, -v48, v46, v34
    v_fma_f32 v34, v49, v47, v48
    v_mul_f32 v50, v35, v47
    v_fma_f32 v51, -v50, v46, v35
    v_fma_f32 v35, v51, v47, v50
    v_mul_f32 v48, v36, v47
    v_fma_f32 v49, -v48, v46, v36
    v_fma_f32 v36, v49, v47, v48
    v_mul_f32 v50, v37, v47
    v_fma_f32 v51, -v50, v46, v37
    v_fma_f32 v37, v51, v47, v50
    v_mul_f32 v48, v38, v47
    v_fma_f32 v49, -v48, v46, v38
    v_fma_f32 v38, v49, v47, v48
    v_mul_f32 v50, v39, v47
    v_fma_f32 v51, -v50, v46, v39
    v_fma_f32 v39, v51, v47, v50
    v_cvt_pk_bf16_f32 v60, v32, v33
    v_cvt_pk_bf16_f32 v61, v34, v35
    v_cvt_pk_bf16_f32 v62, v36, v37
    v_cvt_pk_bf16_f32 v63, v38, v39
    v_lshlrev_b32 v6, 4, v1
    ds_write_b128 v6, v[60:63] offset:0
    s_waitcnt lgkmcnt(0)
L_ln_skip:
    v_lshrrev_b32 v6, 4, v1
    v_lshlrev_b32 v6, 2, v6
    s_lshl_b32 s81, s3, 7
    s_lshr_b32 s97, s26, 1
    s_lshl_b32 s97, s97, 5
    s_add_u32 s81, s81, s97
    v_add_u32 v7, s81, v6
    s_and_b32 s81, s82, 7
    s_lshl_b32 s81, s81, 7
    s_lshl_b32 s97, s26, 4
    s_add_u32 s81, s81, s97
    v_add_u32 v6, s81, v6
    s_barrier
    ds_read_b32 v16, v7 offset:0
    ds_read_b32 v17, v7 offset:16
    ds_read_b32 v18, v6 offset:0
    s_waitcnt lgkmcnt(0)
    s_mov_b32 s80, 32768
    buffer_load_dwordx4 v[84:87], v2, s[28:31], s80 offen offset:1024 nt
    s_waitcnt vmcnt(7)
    s_mov_b32 s80, 32768
    buffer_load_dwordx4 v[88:91], v2, s[28:31], s80 offen offset:2048 nt
    s_waitcnt vmcnt(7)
    v_perm_b32 v48, v16, v16, v12
    v_perm_b32 v49, v16, v16, v13
    v_perm_b32 v50, v16, v16, v14
    v_perm_b32 v51, v16, v16, v15
    s_nop 1
    v_mfma_f32_16x16x32_bf16 v[56:59], v[248:251], v[48:51], 0
    v_perm_b32 v52, v17, v17, v12
    v_perm_b32 v53, v17, v17, v13
    v_perm_b32 v54, v17, v17, v14
    v_perm_b32 v55, v17, v17, v15
    s_nop 1
    v_mfma_f32_16x16x32_bf16 v[56:59], v[252:255], v[52:55], v[56:59]
    v_perm_b32 v32, v18, v18, v12
    v_perm_b32 v33, v18, v18, v13
    v_perm_b32 v34, v18, v18, v14
    v_perm_b32 v35, v18, v18, v15
    s_nop 1
    v_mfma_f32_16x16x32_bf16 v[44:47], v[244:247], v[32:35], 0
    v_lshrrev_b32 v6, 4, v1
    v_lshlrev_b32 v6, 6, v6
    v_and_b32 v7, 15, v1
    v_lshl_add_u32 v6, v7, 2, v6
    s_lshl_b32 s81, s26, 8
    v_add_u32 v6, s81, v6
    v_add_f32_dpp v60, v57, v56 row_ror:8 row_mask:0xf bank_mask:0xf
    v_add_f32_dpp v61, v59, v58 row_ror:8 row_mask:0xf bank_mask:0xf
    v_add_f32_dpp v62, v45, v44 row_ror:8 row_mask:0xf bank_mask:0xf
    v_add_f32_dpp v63, v47, v46 row_ror:8 row_mask:0xf bank_mask:0xf
    s_mov_b32 exec_lo, 0x00ff00ff
    s_mov_b32 exec_hi, 0x00ff00ff
    ds_write_b32 v6, v60 offset:1024
    ds_write_b32 v6, v61 offset:1056
    ds_write_b32 v6, v62 offset:7424
    ds_write_b32 v6, v63 offset:7456
    s_mov_b64 exec, -1
    s_waitcnt lgkmcnt(0)
    s_barrier
    s_cmp_lg_u32 s26, 0
    s_cbranch_scc1 L_pubq_skip
    v_lshlrev_b32 v6, 3, v1
    ds_read_b64 v[32:33], v6 offset:1024
    ds_read_b64 v[34:35], v6 offset:1536
    ds_read_b64 v[36:37], v6 offset:2048
    ds_read_b64 v[38:39], v6 offset:2560
    s_waitcnt lgkmcnt(0)
    v_pk_add_f32 v[32:33], v[32:33], v[34:35]
    v_pk_add_f32 v[36:37], v[36:37], v[38:39]
    v_pk_add_f32 v[32:33], v[32:33], v[36:37]
    v_min_u32 v32, -2, v32
    v_min_u32 v33, -2, v33
    buffer_store_dwordx2 v[32:33], v6, s[56:59], 0 offen offset:0 sc1
    s_nop 0
L_pubq_skip:
    s_cmp_lg_u32 s26, 0
    s_cbranch_scc1 L_pubh_skip
    v_lshlrev_b32 v6, 2, v1
    ds_read_b32 v32, v6 offset:7424
    ds_read_b32 v33, v6 offset:7680
    ds_read_b32 v34, v6 offset:7936
    ds_read_b32 v35, v6 offset:8192
    ds_read_b32 v36, v6 offset:8448
    ds_read_b32 v37, v6 offset:8704
    ds_read_b32 v38, v6 offset:8960
    ds_read_b32 v39, v6 offset:9216
    s_waitcnt lgkmcnt(0)
    v_pk_add_f32 v[32:33], v[32:33], v[34:35]
    v_pk_add_f32 v[36:37], v[36:37], v[38:39]
    v_pk_add_f32 v[32:33], v[32:33], v[36:37]
    v_add_f32 v32, v32, v33
    v_min_u32 v32, -2, v32
    buffer_store_dword v32, v6, s[60:63], 0 offen offset:2048 sc1
    s_nop 0
L_pubh_skip:
    s_lshr_b32 s97, s82, 3
    s_lshl_b32 s97, s97, 15
    s_and_b32 s81, s82, 7
    s_lshl_b32 s81, s81, 5
    s_add_u32 s97, s97, s81
    s_add_u32 s97, s97, 0x100800
    s_add_u32 s44, s24, s97
    s_addc_u32 s45, s25, 0
    s_mov_b32 s46, 0
    s_mov_b32 s47, 0x20000
    s_mul_i32 s46, s101, 28704
    s_mov_b32 s80, 32768
    buffer_load_dwordx4 v[92:95], v2, s[28:31], s80 offen offset:3072 nt
    s_waitcnt vmcnt(7)
    s_cmp_lg_u32 s26, 0
    s_cbranch_scc1 L_bump_skip
    v_mov_b32 v6, 1
    v_mov_b32 v7, 0
    s_lshl_b32 s80, s27, 2
    s_mov_b64 exec, 1
    buffer_atomic_add v6, v7, s[68:71], s80 offen sc1
    s_mov_b64 exec, -1
L_bump_skip:
    s_barrier
    s_mov_b32 s80, 65536
    buffer_load_dwordx4 v[96:99], v2, s[28:31], s80 offen offset:0 nt
    s_waitcnt vmcnt(7)
    s_mov_b32 s80, 65536
    buffer_load_dwordx4 v[100:103], v2, s[28:31], s80 offen offset:1024 nt
    s_waitcnt vmcnt(7)
    s_mov_b32 s80, 65536
    buffer_load_dwordx4 v[104:107], v2, s[28:31], s80 offen offset:2048 nt
    s_waitcnt vmcnt(7)
    s_mov_b32 s80, 65536
    buffer_load_dwordx4 v[108:111], v2, s[28:31], s80 offen offset:3072 nt
    s_waitcnt vmcnt(7)
    s_barrier
    s_mov_b32 s80, 98304
    buffer_load_dwordx4 v[112:115], v2, s[28:31], s80 offen offset:0 nt
    s_waitcnt vmcnt(7)
    s_mov_b32 s80, 98304
    buffer_load_dwordx4 v[116:119], v2, s[28:31], s80 offen offset:1024 nt
    s_waitcnt vmcnt(7)
    s_mov_b32 s80, 98304
    buffer_load_dwordx4 v[120:123], v2, s[28:31], s80 offen offset:2048 nt
    s_waitcnt vmcnt(7)
    s_mov_b32 s80, 98304
    buffer_load_dwordx4 v[124:127], v2, s[28:31], s80 offen offset:3072 nt
    s_waitcnt vmcnt(7)
    s_barrier
    s_mov_b32 s80, 131072
    buffer_load_dwordx4 v[128:131], v2, s[28:31], s80 offen offset:0 nt
    s_waitcnt vmcnt(7)
    s_mov_b32 s80, 131072
    buffer_load_dwordx4 v[132:135], v2, s[28:31], s80 offen offset:1024 nt
    s_waitcnt vmcnt(7)
    s_mov_b32 s80, 131072
    buffer_load_dwordx4 v[136:139], v2, s[28:31], s80 offen offset:2048 nt
    s_waitcnt vmcnt(7)
    s_mov_b32 s80, 131072
    buffer_load_dwordx4 v[140:143], v2, s[28:31], s80 offen offset:3072 nt
    s_waitcnt vmcnt(7)
    s_barrier
    s_mov_b32 s80, 163840
    buffer_load_dwordx4 v[144:147], v2, s[28:31], s80 offen offset:0 nt
    s_waitcnt vmcnt(7)
    s_cmp_lg_u32 s26, 1
    s_cbranch_scc1 L_ldcnth_skip
    v_mov_b32 v7, 0
    s_lshl_b32 s80, s27, 2
    buffer_load_dword v39, v7, s[68:71], s80 offen sc1
L_ldcnth_skip:
    s_mov_b32 s80, 163840
    buffer_load_dwordx4 v[148:151], v2, s[28:31], s80 offen offset:1024 nt
    s_waitcnt vmcnt(7)
    s_mov_b32 s80, 163840
    buffer_load_dwordx4 v[152:155], v2, s[28:31], s80 offen offset:2048 nt
    s_waitcnt vmcnt(7)
    s_barrier
    s_cmp_lg_u32 s26, 2
    s_cbranch_scc1 L_ldcnta_skip
    v_lshlrev_b32 v7, 2, v1
    buffer_load_dword v63, v7, s[68:71], 0 offen sc1
    s_nop 0
L_ldcnta_skip:
    s_mov_b32 s80, 163840
    buffer_load_dwordx4 v[156:159], v2, s[28:31], s80 offen offset:3072 nt
    s_waitcnt vmcnt(7)
    s_mov_b32 s80, 196608
    buffer_load_dwordx4 v[160:163], v2, s[28:31], s80 offen offset:0 nt
    s_waitcnt vmcnt(7)
    s_mov_b32 s80, 196608
    buffer_load_dwordx4 v[164:167], v2, s[28:31], s80 offen offset:1024 nt
    s_waitcnt vmcnt(7)
    s_barrier
    s_mov_b32 s80, 196608
    buffer_load_dwordx4 v[168:171], v2, s[28:31], s80 offen offset:2048 nt
    s_waitcnt vmcnt(7)
    s_mov_b32 s80, 196608
    buffer_load_dwordx4 v[172:175], v2, s[28:31], s80 offen offset:3072 nt
    s_waitcnt vmcnt(7)
    s_mov_b32 s80, 229376
    buffer_load_dwordx4 v[176:179], v2, s[28:31], s80 offen offset:0 nt
    s_waitcnt vmcnt(7)
    s_cmp_lg_u32 s26, 1
    s_cbranch_scc1 L_cnth_skip
    s_mov_b32 s97, 0
L_cnth_loop:
    v_readfirstlane_b32 s81, v39
    s_cmp_ge_u32 s81, 8
    s_nop 3
    s_cbranch_scc1 L_cnth_ok
    s_add_u32 s97, s97, 1
    s_cmp_gt_u32 s97, 200000
    s_cbranch_scc1 L_cnth_ok
    v_mov_b32 v7, 0
    s_lshl_b32 s80, s27, 2
    buffer_load_dword v39, v7, s[68:71], s80 offen sc1
    s_waitcnt vmcnt(0)
    s_branch L_cnth_loop
L_cnth_ok:
L_cnth_skip:
    s_barrier
    s_mov_b32 s80, 229376
    buffer_load_dwordx4 v[180:183], v2, s[28:31], s80 offen offset:1024 nt
    s_waitcnt vmcnt(7)
    s_barrier
    v_lshlrev_b32 v7, 3, v1
    s_lshl_b32 s80, s26, 11
    buffer_load_dwordx2 v[48:49], v7, s[64:67], s80 offen offset:0 sc1
    s_waitcnt vmcnt(7)
    s_cmp_lg_u32 s26, 2
    s_cbranch_scc1 L_cnta_skip
    s_mov_b32 s97, 0
L_cnta_loop:
    v_cmp_gt_u32 vcc, 8, v63
    s_and_b32 vcc_hi, vcc_hi, 0
    s_cmp_eq_u32 vcc_lo, 0
    s_nop 2
    s_cbranch_scc1 L_cnta_ok
    s_add_u32 s97, s97, 1
    s_cmp_gt_u32 s97, 200000
    s_cbranch_scc1 L_cnta_ok
    v_lshlrev_b32 v7, 2, v1
    buffer_load_dword v63, v7, s[68:71], 0 offen sc1
    s_waitcnt vmcnt(0)
    s_branch L_cnta_loop
L_cnta_ok:
L_cnta_skip:
    s_barrier
    s_cmp_lg_u32 s26, 3
    s_cbranch_scc1 L_ldhpg_skip
    v_and_b32 v6, 7, v1
    v_lshlrev_b32 v6, 12, v6
    v_lshrrev_b32 v7, 4, v1
    v_lshl_add_u32 v6, v7, 3, v6
    buffer_load_dwordx2 v[240:241], v6, s[44:47], 0 offen sc1
    s_nop 0
L_ldhpg_skip:
    s_mov_b32 s80, 229376
    buffer_load_dwordx4 v[184:187], v2, s[28:31], s80 offen offset:2048 nt
    s_waitcnt vmcnt(7)
    v_lshrrev_b32 v6, 4, v1
    v_lshlrev_b32 v6, 11, v6
    v_and_b32 v7, 1, v1
    v_lshl_add_u32 v6, v7, 10, v6
    v_bfe_u32 v7, v1, 1, 3
    v_lshl_add_u32 v6, v7, 4, v6
    s_lshl_b32 s81, s26, 7
    v_add_u32 v6, s81, v6
    buffer_load_dwordx4 v[244:247], v6, s[48:51], 0 offen nt
    s_waitcnt vmcnt(7)
    s_barrier
    s_mov_b32 s80, 229376
    buffer_load_dwordx4 v[188:191], v2, s[28:31], s80 offen offset:3072 nt
    s_waitcnt vmcnt(7)
    s_mov_b32 s80, 0
    s_add_u32 m0, s95, 0
    s_nop 0
    buffer_load_dwordx4 v3, s[32:35], s80 offen offset:0 nt lds
    s_waitcnt vmcnt(7)
    s_mov_b32 s80, 0
    s_add_u32 m0, s95, 0
    s_nop 0
    buffer_load_dwordx4 v3, s[32:35], s80 offen offset:1024 nt lds
    s_waitcnt vmcnt(7)
    s_mov_b32 s80, 0
    s_add_u32 m0, s95, 0
    s_nop 0
    buffer_load_dwordx4 v3, s[32:35], s80 offen offset:2048 nt lds
    s_waitcnt vmcnt(7)
    s_barrier
    s_mov_b32 s80, 0
    s_add_u32 m0, s95, 0
    s_nop 0
    buffer_load_dwordx4 v3, s[32:35], s80 offen offset:3072 nt lds
    s_waitcnt vmcnt(7)
    s_mov_b32 s97, 0
L_qp_loop:
    v_cmp_eq_u32 vcc, -1, v48
    v_cmp_eq_u32 s[98:99], -1, v49
    s_or_b64 vcc, vcc, s[98:99]
    s_cmp_eq_u64 vcc, 0
    s_nop 2
    s_cbranch_scc1 L_qp_ok
    s_add_u32 s97, s97, 1
    s_cmp_gt_u32 s97, 200000
    s_cbranch_scc1 L_qp_ok
    s_mov_b64 exec, vcc
    v_lshlrev_b32 v7, 3, v1
    s_lshl_b32 s80, s26, 11
    buffer_load_dwordx2 v[48:49], v7, s[64:67], s80 offen offset:0 sc1
    s_mov_b64 exec, -1
    s_waitcnt vmcnt(0)
    s_branch L_qp_loop
L_qp_ok:
    v_lshlrev_b32 v6, 3, v1
    s_lshl_b32 s81, s26, 9
    v_add_u32 v7, s81, v6
    ds_write_b64 v7, v[48:49] offset:1024
    s_waitcnt lgkmcnt(0)
    s_barrier
    ds_read_b64 v[16:17], v6 offset:1024
    ds_read_b64 v[18:19], v6 offset:1536
    ds_read_b64 v[20:21], v6 offset:2048
    ds_read_b64 v[22:23], v6 offset:2560
    ds_read_b64 v[24:25], v6 offset:3072
    ds_read_b64 v[26:27], v6 offset:3584
    ds_read_b64 v[28:29], v6 offset:4096
    ds_read_b64 v[30:31], v6 offset:4608
    s_waitcnt lgkmcnt(0)
    v_pk_add_f32 v[16:17], v[16:17], v[18:19]
    v_pk_add_f32 v[20:21], v[20:21], v[22:23]
    v_pk_add_f32 v[24:25], v[24:25], v[26:27]
    v_pk_add_f32 v[28:29], v[28:29], v[30:31]
    v_pk_add_f32 v[16:17], v[16:17], v[20:21]
    v_pk_add_f32 v[24:25], v[24:25], v[28:29]
    v_pk_add_f32 v[16:17], v[16:17], v[24:25]
    v_cvt_pk_bf16_f32 v32, v16, v17
    s_lshl_b32 s81, s26, 8
    v_lshlrev_b32 v7, 2, v1
    v_add_u32 v7, s81, v7
    ds_write_b32 v7, v32 offset:5120
    v_lshrrev_b32 v6, 4, v1
    v_lshlrev_b32 v6, 6, v6
    v_and_b32 v7, 3, v1
    v_lshl_add_u32 v6, v7, 4, v6
    v_add_u32 v6, s81, v6
    s_waitcnt lgkmcnt(0)
    ds_read_b128 v[40:43], v6 offset:5120
    s_waitcnt lgkmcnt(0)
    v_cndmask_b32 v16, 0, v40, s[84:85]
    v_cndmask_b32 v17, 0, v41, s[84:85]
    v_cndmask_b32 v18, 0, v42, s[84:85]
    v_cndmask_b32 v19, 0, v43, s[84:85]
    v_cndmask_b32 v20, 0, v40, s[86:87]
    v_cndmask_b32 v21, 0, v41, s[86:87]
    v_cndmask_b32 v22, 0, v42, s[86:87]
    v_cndmask_b32 v23, 0, v43, s[86:87]
    v_cndmask_b32 v24, 0, v40, s[88:89]
    v_cndmask_b32 v25, 0, v41, s[88:89]
    v_cndmask_b32 v26, 0, v42, s[88:89]
    v_cndmask_b32 v27, 0, v43, s[88:89]
    v_cndmask_b32 v28, 0, v40, s[90:91]
    v_cndmask_b32 v29, 0, v41, s[90:91]
    v_cndmask_b32 v30, 0, v42, s[90:91]
    v_cndmask_b32 v31, 0, v43, s[90:91]
    v_mfma_f32_16x16x32_bf16 v[40:43], v[64:67], v[16:19], 0
    v_mfma_f32_16x16x32_bf16 v[40:43], v[68:71], v[20:23], v[40:43]
    v_mfma_f32_16x16x32_bf16 v[40:43], v[72:75], v[24:27], v[40:43]
    v_mfma_f32_16x16x32_bf16 v[40:43], v[76:79], v[28:31], v[40:43]
    v_mfma_f32_16x16x32_bf16 v[44:47], v[80:83], v[16:19], 0
    v_mfma_f32_16x16x32_bf16 v[44:47], v[84:87], v[20:23], v[44:47]
    v_mfma_f32_16x16x32_bf16 v[44:47], v[88:91], v[24:27], v[44:47]
    v_mfma_f32_16x16x32_bf16 v[44:47], v[92:95], v[28:31], v[44:47]
    s_nop 3
    v_mov_b32_dpp v32, v40 quad_perm:[0,0,0,0] row_mask:0xf bank_mask:0xf
    s_nop 1
    v_add_f32_dpp v32, v41, v32 quad_perm:[1,1,1,1] row_mask:0xf bank_mask:0xf
    s_nop 1
    v_add_f32_dpp v32, v42, v32 quad_perm:[2,2,2,2] row_mask:0xf bank_mask:0xf
    s_nop 1
    v_add_f32_dpp v32, v43, v32 quad_perm:[3,3,3,3] row_mask:0xf bank_mask:0xf
    v_mfma_f32_16x16x32_bf16 v[40:43], v[96:99], v[16:19], 0
    v_mfma_f32_16x16x32_bf16 v[40:43], v[100:103], v[20:23], v[40:43]
    v_mfma_f32_16x16x32_bf16 v[40:43], v[104:107], v[24:27], v[40:43]
    v_mfma_f32_16x16x32_bf16 v[40:43], v[108:111], v[28:31], v[40:43]
    v_mov_b32_dpp v33, v44 quad_perm:[0,0,0,0] row_mask:0xf bank_mask:0xf
    s_nop 1
    v_add_f32_dpp v33, v45, v33 quad_perm:[1,1,1,1] row_mask:0xf bank_mask:0xf
    s_nop 1
    v_add_f32_dpp v33, v46, v33 quad_perm:[2,2,2,2] row_mask:0xf bank_mask:0xf
    s_nop 1
    v_add_f32_dpp v33, v47, v33 quad_perm:[3,3,3,3] row_mask:0xf bank_mask:0xf
    v_mfma_f32_16x16x32_bf16 v[44:47], v[112:115], v[16:19], 0
    v_mfma_f32_16x16x32_bf16 v[44:47], v[116:119], v[20:23], v[44:47]
    v_mfma_f32_16x16x32_bf16 v[44:47], v[120:123], v[24:27], v[44:47]
    v_mfma_f32_16x16x32_bf16 v[44:47], v[124:127], v[28:31], v[44:47]
    v_mov_b32_dpp v34, v40 quad_perm:[0,0,0,0] row_mask:0xf bank_mask:0xf
    s_nop 1
    v_add_f32_dpp v34, v41, v34 quad_perm:[1,1,1,1] row_mask:0xf bank_mask:0xf
    s_nop 1
    v_add_f32_dpp v34, v42, v34 quad_perm:[2,2,2,2] row_mask:0xf bank_mask:0xf
    s_nop 1
    v_add_f32_dpp v34, v43, v34 quad_perm:[3,3,3,3] row_mask:0xf bank_mask:0xf
    v_mfma_f32_16x16x32_bf16 v[40:43], v[128:131], v[16:19], 0
    v_mfma_f32_16x16x32_bf16 v[40:43], v[132:135], v[20:23], v[40:43]
    v_mfma_f32_16x16x32_bf16 v[40:43], v[136:139], v[24:27], v[40:43]
    v_mfma_f32_16x16x32_bf16 v[40:43], v[140:143], v[28:31], v[40:43]
    v_mov_b32_dpp v35, v44 quad_perm:[0,0,0,0] row_mask:0xf bank_mask:0xf
    s_nop 1
    v_add_f32_dpp v35, v45, v35 quad_perm:[1,1,1,1] row_mask:0xf bank_mask:0xf
    s_nop 1
    v_add_f32_dpp v35, v46, v35 quad_perm:[2,2,2,2] row_mask:0xf bank_mask:0xf
    s_nop 1
    v_add_f32_dpp v35, v47, v35 quad_perm:[3,3,3,3] row_mask:0xf bank_mask:0xf
    v_mfma_f32_16x16x32_bf16 v[44:47], v[144:147], v[16:19], 0
    v_mfma_f32_16x16x32_bf16 v[44:47], v[148:151], v[20:23], v[44:47]
    v_mfma_f32_16x16x32_bf16 v[44:47], v[152:155], v[24:27], v[44:47]
    v_mfma_f32_16x16x32_bf16 v[44:47], v[156:159], v[28:31], v[44:47]
    v_mov_b32_dpp v36, v40 quad_perm:[0,0,0,0] row_mask:0xf bank_mask:0xf
    s_nop 1
    v_add_f32_dpp v36, v41, v36 quad_perm:[1,1,1,1] row_mask:0xf bank_mask:0xf
    s_nop 1
    v_add_f32_dpp v36, v42, v36 quad_perm:[2,2,2,2] row_mask:0xf bank_mask:0xf
    s_nop 1
    v_add_f32_dpp v36, v43, v36 quad_perm:[3,3,3,3] row_mask:0xf bank_mask:0xf
    v_mfma_f32_16x16x32_bf16 v[40:43], v[160:163], v[16:19], 0
    v_mfma_f32_16x16x32_bf16 v[40:43], v[164:167], v[20:23], v[40:43]
    v_mfma_f32_16x16x32_bf16 v[40:43], v[168:171], v[24:27], v[40:43]
    v_mfma_f32_16x16x32_bf16 v[40:43], v[172:175], v[28:31], v[40:43]
    v_mov_b32_dpp v37, v44 quad_perm:[0,0,0,0] row_mask:0xf bank_mask:0xf
    s_nop 1
    v_add_f32_dpp v37, v45, v37 quad_perm:[1,1,1,1] row_mask:0xf bank_mask:0xf
    s_nop 1
    v_add_f32_dpp v37, v46, v37 quad_perm:[2,2,2,2] row_mask:0xf bank_mask:0xf
    s_nop 1
    v_add_f32_dpp v37, v47, v37 quad_perm:[3,3,3,3] row_mask:0xf bank_mask:0xf
    s_mov_b32 s80, 32768
    s_add_u32 m0, s95, 4096
    s_nop 0
    buffer_load_dwordx4 v3, s[32:35], s80 offen offset:0 nt lds
    s_waitcnt vmcnt(7)
    s_mov_b32 s80, 32768
    s_add_u32 m0, s95, 4096
    s_nop 0
    buffer_load_dwordx4 v3, s[32:35], s80 offen offset:1024 nt lds
    s_waitcnt vmcnt(7)
    s_cmp_lg_u32 s26, 3
    s_cbranch_scc1 L_hp4_skip
    s_mov_b32 s97, 0
L_hp_loop:
    v_cmp_eq_u32 vcc, -1, v240
    v_cmp_eq_u32 s[98:99], -1, v241
    s_or_b64 vcc, vcc, s[98:99]
    s_cmp_eq_u64 vcc, 0
    s_nop 2
    s_cbranch_scc1 L_hp_ok
    s_add_u32 s97, s97, 1
    s_cmp_gt_u32 s97, 200000
    s_cbranch_scc1 L_hp_ok
    s_mov_b64 exec, vcc
    v_and_b32 v6, 7, v1
    v_lshlrev_b32 v6, 12, v6
    v_lshrrev_b32 v7, 4, v1
    v_lshl_add_u32 v6, v7, 3, v6
    buffer_load_dwordx2 v[240:241], v6, s[44:47], 0 offen sc1
    s_mov_b64 exec, -1
    s_waitcnt vmcnt(0)
    s_branch L_hp_loop
L_hp_ok:
    v_add_f32_dpp v240, v240, v240 quad_perm:[1,0,3,2] row_mask:0xf bank_mask:0xf
    v_add_f32_dpp v241, v241, v241 quad_perm:[1,0,3,2] row_mask:0xf bank_mask:0xf
    s_nop 0
    v_add_f32_dpp v240, v240, v240 quad_perm:[2,3,0,1] row_mask:0xf bank_mask:0xf
    v_add_f32_dpp v241, v241, v241 quad_perm:[2,3,0,1] row_mask:0xf bank_mask:0xf
    s_nop 0
    v_add_f32_dpp v240, v240, v240 row_half_mirror row_mask:0xf bank_mask:0xf
    v_add_f32_dpp v241, v241, v241 row_half_mirror row_mask:0xf bank_mask:0xf
    v_cvt_pk_bf16_f32 v240, v240, v240
    v_and_b32 v240, 0xffff0000, v240
    v_mul_f32 v60, 0xbfb8aa3b, v240
    v_min_f32 v60, 0x42fe0000, v60
    v_exp_f32 v60, v60
    s_nop 0
    v_add_f32 v60, 1.0, v60
    v_rcp_f32 v61, v60
    s_nop 0
    v_mul_f32 v242, v240, v61
    v_fma_f32 v240, -v242, v60, v240
    v_fma_f32 v240, v240, v61, v242
    v_cvt_pk_bf16_f32 v241, v241, v241
    v_and_b32 v241, 0xffff0000, v241
    v_mul_f32 v60, 0xbfb8aa3b, v241
    v_min_f32 v60, 0x42fe0000, v60
    v_exp_f32 v60, v60
    s_nop 0
    v_add_f32 v60, 1.0, v60
    v_rcp_f32 v61, v60
    s_nop 0
    v_mul_f32 v242, v241, v61
    v_fma_f32 v241, -v242, v60, v241
    v_fma_f32 v241, v241, v61, v242
    v_cvt_pk_bf16_f32 v240, v240, v241
    v_lshrrev_b32 v6, 4, v1
    v_lshlrev_b32 v6, 2, v6
    ds_write_b32 v6, v240 offset:10304
    s_waitcnt lgkmcnt(0)
L_hp4_skip:
    v_lshrrev_b32 v6, 4, v1
    v_lshlrev_b32 v6, 2, v6
    s_barrier
    ds_read_b32 v240, v6 offset:10304
    s_waitcnt lgkmcnt(0)
    v_perm_b32 v52, v240, v240, v12
    v_perm_b32 v53, v240, v240, v13
    v_perm_b32 v54, v240, v240, v14
    v_perm_b32 v55, v240, v240, v15
    s_nop 1
    v_mfma_f32_16x16x32_bf16 v[240:243], v[244:247], v[52:55], 0
    s_nop 7
    v_add_f32_dpp v60, v241, v240 row_ror:8 row_mask:0xf bank_mask:0xf
    v_add_f32_dpp v61, v243, v242 row_ror:8 row_mask:0xf bank_mask:0xf
    v_min_u32 v60, -2, v60
    v_min_u32 v61, -2, v61
    s_cmp_eq_u32 s101, 0
    s_nop 0
    s_cbranch_scc1 L_gp_skip
    buffer_store_dwordx2 v[60:61], v5, s[60:63], 0 offen offset:0 sc1
L_gp_skip:
    s_mov_b32 s80, 32768
    s_add_u32 m0, s95, 4096
    s_nop 0
    buffer_load_dwordx4 v3, s[32:35], s80 offen offset:2048 nt lds
    s_waitcnt vmcnt(7)
    v_mfma_f32_16x16x32_bf16 v[44:47], v[176:179], v[16:19], 0
    v_mfma_f32_16x16x32_bf16 v[44:47], v[180:183], v[20:23], v[44:47]
    v_mfma_f32_16x16x32_bf16 v[44:47], v[184:187], v[24:27], v[44:47]
    v_mfma_f32_16x16x32_bf16 v[44:47], v[188:191], v[28:31], v[44:47]
    v_mov_b32_dpp v38, v40 quad_perm:[0,0,0,0] row_mask:0xf bank_mask:0xf
    s_nop 1
    v_add_f32_dpp v38, v41, v38 quad_perm:[1,1,1,1] row_mask:0xf bank_mask:0xf
    s_nop 1
    v_add_f32_dpp v38, v42, v38 quad_perm:[2,2,2,2] row_mask:0xf bank_mask:0xf
    s_nop 1
    v_add_f32_dpp v38, v43, v38 quad_perm:[3,3,3,3] row_mask:0xf bank_mask:0xf
    v_mov_b32_dpp v39, v44 quad_perm:[0,0,0,0] row_mask:0xf bank_mask:0xf
    s_nop 1
    v_add_f32_dpp v39, v45, v39 quad_perm:[1,1,1,1] row_mask:0xf bank_mask:0xf
    s_nop 1
    v_add_f32_dpp v39, v46, v39 quad_perm:[2,2,2,2] row_mask:0xf bank_mask:0xf
    s_nop 1
    v_add_f32_dpp v39, v47, v39 quad_perm:[3,3,3,3] row_mask:0xf bank_mask:0xf
    v_cvt_pk_bf16_f32 v60, v32, v33
    v_lshlrev_b32 v32, 16, v60
    v_and_b32 v33, 0xffff0000, v60
    v_mul_f32 v32, 0x3db504f3, v32
    v_mul_f32 v33, 0x3db504f3, v33
    v_cvt_pk_bf16_f32 v60, v32, v33
    v_lshlrev_b32 v32, 16, v60
    v_and_b32 v33, 0xffff0000, v60
    v_cvt_pk_bf16_f32 v60, v34, v35
    v_lshlrev_b32 v34, 16, v60
    v_and_b32 v35, 0xffff0000, v60
    v_mul_f32 v34, 0x3db504f3, v34
    v_mul_f32 v35, 0x3db504f3, v35
    v_cvt_pk_bf16_f32 v60, v34, v35
    v_lshlrev_b32 v34, 16, v60
    v_and_b32 v35, 0xffff0000, v60
    v_cvt_pk_bf16_f32 v60, v36, v37
    v_lshlrev_b32 v36, 16, v60
    v_and_b32 v37, 0xffff0000, v60
    v_mul_f32 v36, 0x3db504f3, v36
    v_mul_f32 v37, 0x3db504f3, v37
    v_cvt_pk_bf16_f32 v60, v36, v37
    v_lshlrev_b32 v36, 16, v60
    v_and_b32 v37, 0xffff0000, v60
    v_cvt_pk_bf16_f32 v60, v38, v39
    v_lshlrev_b32 v38, 16, v60
    v_and_b32 v39, 0xffff0000, v60
    v_mul_f32 v38, 0x3db504f3, v38
    v_mul_f32 v39, 0x3db504f3, v39
    v_cvt_pk_bf16_f32 v60, v38, v39
    v_lshlrev_b32 v38, 16, v60
    v_and_b32 v39, 0xffff0000, v60
    v_max3_f32 v60, v32, v33, v34
    v_max3_f32 v60, v60, v35, v36
    v_max3_f32 v60, v60, v37, v38
    v_max_f32 v60, v60, v39
    s_nop 1
    v_max_f32_dpp v60, v60, v60 row_ror:8 row_mask:0xf bank_mask:0xf
    s_nop 1
    v_max_f32_dpp v60, v60, v60 row_ror:4 row_mask:0xf bank_mask:0xf
    s_nop 1
    v_max_f32_dpp v60, v60, v60 row_bcast:15 row_mask:0xa bank_mask:0xf
    s_nop 1
    v_max_f32_dpp v60, v60, v60 row_bcast:31 row_mask:0xc bank_mask:0xf
    s_nop 0
    v_readlane_b32 s81, v60, 63
    s_lshl_b32 s97, s26, 2
    v_mov_b32 v6, s97
    v_mov_b32 v60, s81
    ds_write_b32 v6, v60 offset:7168
    s_waitcnt lgkmcnt(0)
    s_barrier
    v_mov_b32 v7, 0
    ds_read_b128 v[40:43], v7 offset:7168
    ds_read_b128 v[44:47], v7 offset:7184
    s_waitcnt lgkmcnt(0)
    v_max3_f32 v62, v40, v41, v42
    v_max3_f32 v62, v62, v43, v44
    v_max3_f32 v62, v62, v45, v46
    v_max_f32 v62, v62, v47
    v_sub_f32 v32, v32, v62
    v_mul_f32 v32, 0x3fb8aa3b, v32
    v_sub_f32 v33, v33, v62
    v_mul_f32 v33, 0x3fb8aa3b, v33
    v_sub_f32 v34, v34, v62
    v_mul_f32 v34, 0x3fb8aa3b, v34
    v_sub_f32 v35, v35, v62
    v_mul_f32 v35, 0x3fb8aa3b, v35
    v_sub_f32 v36, v36, v62
    v_mul_f32 v36, 0x3fb8aa3b, v36
    v_sub_f32 v37, v37, v62
    v_mul_f32 v37, 0x3fb8aa3b, v37
    v_sub_f32 v38, v38, v62
    v_mul_f32 v38, 0x3fb8aa3b, v38
    v_sub_f32 v39, v39, v62
    v_mul_f32 v39, 0x3fb8aa3b, v39
    v_exp_f32 v32, v32
    v_exp_f32 v33, v33
    v_exp_f32 v34, v34
    v_exp_f32 v35, v35
    v_exp_f32 v36, v36
    v_exp_f32 v37, v37
    v_exp_f32 v38, v38
    v_exp_f32 v39, v39
    v_add_f32 v60, v32, v33
    v_add_f32 v61, v34, v35
    v_add_f32 v40, v36, v37
    v_add_f32 v41, v38, v39
    v_add_f32 v60, v60, v61
    v_add_f32 v40, v40, v41
    v_add_f32 v60, v60, v40
    s_nop 1
    v_add_f32_dpp v60, v60, v60 row_ror:8 row_mask:0xf bank_mask:0xf
    s_nop 1
    v_add_f32_dpp v60, v60, v60 row_ror:4 row_mask:0xf bank_mask:0xf
    s_nop 1
    v_add_f32_dpp v60, v60, v60 row_bcast:15 row_mask:0xa bank_mask:0xf
    s_nop 1
    v_add_f32_dpp v60, v60, v60 row_bcast:31 row_mask:0xc bank_mask:0xf
    s_nop 0
    v_readlane_b32 s81, v60, 63
    s_nop 1
    v_mov_b32 v60, s81
    ds_write_b32 v6, v60 offset:7200
    s_waitcnt lgkmcnt(0)
    s_barrier
    s_cmp_lg_u32 s26, 2
    s_cbranch_scc1 L_pubml_skip
    v_mov_b32 v7, 0
    ds_read_b128 v[40:43], v7 offset:7200
    ds_read_b128 v[44:47], v7 offset:7216
    s_waitcnt lgkmcnt(0)
    v_pk_add_f32 v[40:41], v[40:41], v[42:43]
    v_pk_add_f32 v[44:45], v[44:45], v[46:47]
    v_pk_add_f32 v[40:41], v[40:41], v[44:45]
    v_add_f32 v61, v40, v41
    v_min_u32 v60, -2, v62
    v_min_u32 v61, -2, v61
    s_mov_b64 exec, 1
    buffer_store_dwordx2 v[60:61], v7, s[56:59], 0 offen offset:1280 sc1
    s_mov_b64 exec, -1
L_pubml_skip:
    s_barrier
    s_mov_b32 s80, 32768
    s_add_u32 m0, s95, 4096
    s_nop 0
    buffer_load_dwordx4 v3, s[32:35], s80 offen offset:3072 nt lds
    s_waitcnt vmcnt(7)
    s_mov_b32 s80, 65536
    s_add_u32 m0, s95, 8192
    s_nop 0
    buffer_load_dwordx4 v3, s[32:35], s80 offen offset:0 nt lds
    s_waitcnt vmcnt(7)
    s_mov_b32 s80, 65536
    s_add_u32 m0, s95, 8192
    s_nop 0
    buffer_load_dwordx4 v3, s[32:35], s80 offen offset:1024 nt lds
    s_waitcnt vmcnt(7)
    s_mov_b32 s80, 65536
    s_add_u32 m0, s95, 8192
    s_nop 0
    buffer_load_dwordx4 v3, s[32:35], s80 offen offset:2048 nt lds
    s_waitcnt vmcnt(7)
    s_barrier
    s_mov_b32 s80, 65536
    s_add_u32 m0, s95, 8192
    s_nop 0
    buffer_load_dwordx4 v3, s[32:35], s80 offen offset:3072 nt lds
    s_waitcnt vmcnt(7)
    s_mov_b32 s80, 98304
    s_add_u32 m0, s95, 12288
    s_nop 0
    buffer_load_dwordx4 v3, s[32:35], s80 offen offset:0 nt lds
    s_waitcnt vmcnt(7)
    s_mov_b32 s80, 98304
    s_add_u32 m0, s95, 12288
    s_nop 0
    buffer_load_dwordx4 v3, s[32:35], s80 offen offset:1024 nt lds
    s_waitcnt vmcnt(7)
    s_mov_b32 s80, 98304
    s_add_u32 m0, s95, 12288
    s_nop 0
    buffer_load_dwordx4 v3, s[32:35], s80 offen offset:2048 nt lds
    s_waitcnt vmcnt(7)
    s_barrier
    s_cmp_eq_u32 s83, 0
    s_cbranch_scc1 L_gld_skip
    s_lshl_b32 s81, s0, 6
    s_add_u32 s97, s81, 0x100000
    s_add_u32 s72, s24, s97
    s_addc_u32 s73, s25, 0
    s_mov_b32 s74, 716864
    s_mov_b32 s75, 0x20000
    v_lshrrev_b32 v7, 2, v0
    v_lshlrev_b32 v7, 12, v7
    v_and_b32 v6, 3, v0
    v_lshl_add_u32 v178, v6, 4, v7
    s_mov_b32 s96, 524288
    buffer_load_dwordx4 v[156:159], v178, s[72:75], 0 offen sc1
    buffer_load_dwordx4 v[160:163], v178, s[72:75], s96 offen sc1
L_gld_skip:
    s_mov_b32 s80, 98304
    s_add_u32 m0, s95, 12288
    s_nop 0
    buffer_load_dwordx4 v3, s[32:35], s80 offen offset:3072 nt lds
    s_waitcnt vmcnt(7)
    s_mov_b32 s80, 131072
    buffer_load_dwordx4 v[192:195], v3, s[32:35], s80 offen offset:0 nt
    s_waitcnt vmcnt(7)
    s_cmp_lg_u32 s26, 7
    s_cbranch_scc1 L_tailpre_skip
    v_lshlrev_b32 v7, 7, v1
    s_mov_b32 s80, L_tail-L_pc
    s_mov_b32 m0, 12288
    s_mov_b32 exec_lo, 0xffffffff
    s_mov_b32 exec_hi, 0x0
    buffer_load_dword v7, s[76:79], s80 offen lds
    s_mov_b64 exec, -1
L_tailpre_skip:
    s_barrier
    s_mov_b32 s80, 131072
    buffer_load_dwordx4 v[196:199], v3, s[32:35], s80 offen offset:1024 nt
    s_waitcnt vmcnt(7)
    s_mov_b32 s80, 131072
    buffer_load_dwordx4 v[200:203], v3, s[32:35], s80 offen offset:2048 nt
    s_waitcnt vmcnt(7)
    s_mov_b32 s80, 131072
    buffer_load_dwordx4 v[204:207], v3, s[32:35], s80 offen offset:3072 nt
    s_waitcnt vmcnt(7)
    s_mov_b32 s80, 163840
    buffer_load_dwordx4 v[208:211], v3, s[32:35], s80 offen offset:0 nt
    s_waitcnt vmcnt(7)
    s_barrier
    s_cmp_lg_u32 s26, 4
    s_cbranch_scc1 L_ldmlg_skip
    v_and_b32 v6, 7, v1
    v_lshlrev_b32 v6, 11, v6
    buffer_load_dwordx2 v[148:149], v6, s[64:67], 0 offen offset:1280 sc1
    s_nop 0
L_ldmlg_skip:
    s_mov_b32 s80, 163840
    buffer_load_dwordx4 v[212:215], v3, s[32:35], s80 offen offset:1024 nt
    s_waitcnt vmcnt(7)
    s_mov_b32 s80, 163840
    buffer_load_dwordx4 v[216:219], v3, s[32:35], s80 offen offset:2048 nt
    s_waitcnt vmcnt(7)
    s_mov_b32 s80, 163840
    buffer_load_dwordx4 v[220:223], v3, s[32:35], s80 offen offset:3072 nt
    s_waitcnt vmcnt(7)
    s_cmp_eq_u32 s83, 0
    s_cbranch_scc1 L_g_skip
    s_mov_b32 s97, 0
L_g_loop:
    v_cmp_eq_u32 vcc, -1, v156
    v_cmp_eq_u32 s[98:99], -1, v157
    s_or_b64 vcc, vcc, s[98:99]
    v_cmp_eq_u32 s[98:99], -1, v158
    s_or_b64 vcc, vcc, s[98:99]
    v_cmp_eq_u32 s[98:99], -1, v159
    s_or_b64 vcc, vcc, s[98:99]
    v_cmp_eq_u32 s[98:99], -1, v160
    s_or_b64 vcc, vcc, s[98:99]
    v_cmp_eq_u32 s[98:99], -1, v161
    s_or_b64 vcc, vcc, s[98:99]
    v_cmp_eq_u32 s[98:99], -1, v162
    s_or_b64 vcc, vcc, s[98:99]
    v_cmp_eq_u32 s[98:99], -1, v163
    s_or_b64 vcc, vcc, s[98:99]
    s_cmp_eq_u64 vcc, 0
    s_nop 2
    s_cbranch_scc1 L_g_ok
    s_add_u32 s97, s97, 1
    s_cmp_gt_u32 s97, 200000
    s_cbranch_scc1 L_g_ok
    s_mov_b64 exec, vcc
    buffer_load_dwordx4 v[156:159], v178, s[72:75], 0 offen sc1
    buffer_load_dwordx4 v[160:163], v178, s[72:75], s96 offen sc1
    s_mov_b64 exec, -1
    s_waitcnt vmcnt(0)
    s_branch L_g_loop
L_g_ok:
    v_lshrrev_b32 v6, 4, v1
    v_lshlrev_b32 v6, 4, v6
    v_and_b32 v7, 3, v1
    v_lshl_add_u32 v6, v7, 2, v6
    s_lshl_b32 s81, s26, 6
    v_add_u32 v6, s81, v6
    v_add_f32 v156, v156, v160
    v_add_f32 v157, v157, v161
    v_add_f32 v158, v158, v162
    v_add_f32 v159, v159, v163
    s_nop 0
    v_permlane32_swap_b32 v156, v158
    v_permlane32_swap_b32 v157, v159
    v_add_f32 v156, v156, v158
    v_add_f32 v157, v157, v159
    s_nop 1
    v_permlane16_swap_b32 v156, v157
    v_add_f32 v156, v156, v157
    s_nop 1
    v_add_f32_dpp v156, v156, v156 row_ror:8 row_mask:0xf bank_mask:0xf
    s_nop 1
    v_add_f32_dpp v156, v156, v156 row_ror:4 row_mask:0xf bank_mask:0xf
    s_mov_b32 exec_lo, 0x000f000f
    s_mov_b32 exec_hi, 0x000f000f
    ds_write_b32 v6, v156 offset:9472
    s_mov_b64 exec, -1
    s_waitcnt lgkmcnt(0)
    s_barrier
    s_cmp_lg_u32 s26, 0
    s_cbranch_scc1 L_gfin_skip
    v_lshrrev_b32 v6, 4, v1
    v_and_b32 v7, 3, v1
    v_lshl_add_u32 v156, v7, 2, v6
    v_lshrrev_b32 v6, 3, v156
    v_and_b32 v7, 1, v156
    v_lshl_add_u32 v6, v7, 1, v6
    v_bfe_u32 v7, v156, 1, 2
    v_lshl_add_u32 v6, v6, 2, v7
    v_lshlrev_b32 v6, 2, v6
    ds_read_b32 v160, v6 offset:9472
    ds_read_b32 v161, v6 offset:9536
    ds_read_b32 v162, v6 offset:9600
    ds_read_b32 v163, v6 offset:9664
    ds_read_b32 v157, v6 offset:9728
    ds_read_b32 v158, v6 offset:9792
    ds_read_b32 v159, v6 offset:9856
    ds_read_b32 v176, v6 offset:9920
    s_lshl_b32 s81, s0, 4
    v_add_u32 v156, s81, v156
    v_lshlrev_b32 v179, 1, v156
    buffer_load_ushort v177, v179, s[52:55], 0 offen
    s_waitcnt lgkmcnt(0)
    v_pk_add_f32 v[160:161], v[160:161], v[162:163]
    v_add_f32 v157, v157, v158
    v_add_f32 v176, v176, v159
    v_add_f32 v160, v160, v161
    v_add_f32 v176, v176, v157
    v_add_f32 v176, v176, v160
    v_cvt_pk_bf16_f32 v176, v176, v176
    v_and_b32 v176, 0xffff0000, v176
    v_mul_f32 v156, 0xbfb8aa3b, v176
    v_min_f32 v156, 0x42fe0000, v156
    v_exp_f32 v156, v156
    s_nop 0
    v_add_f32 v156, 1.0, v156
    v_rcp_f32 v157, v156
    s_nop 0
    v_mul_f32 v158, v176, v157
    v_fma_f32 v176, -v158, v156, v176
    v_fma_f32 v176, v176, v157, v158
    v_cvt_pk_bf16_f32 v176, v176, v176
    v_and_b32 v176, 0xffff0000, v176
    s_nop 1
L_gfin_skip:
L_g_skip:
    s_barrier
    s_mov_b32 s80, 196608
    buffer_load_dwordx4 v[224:227], v3, s[32:35], s80 offen offset:0 nt
    s_waitcnt vmcnt(7)
    s_mov_b32 s80, 196608
    buffer_load_dwordx4 v[228:231], v3, s[32:35], s80 offen offset:1024 nt
    s_waitcnt vmcnt(7)
    s_mov_b32 s80, 196608
    buffer_load_dwordx4 v[232:235], v3, s[32:35], s80 offen offset:2048 nt
    s_waitcnt vmcnt(7)
    s_mov_b32 s80, 196608
    buffer_load_dwordx4 v[236:239], v3, s[32:35], s80 offen offset:3072 nt
    s_waitcnt vmcnt(7)
    s_barrier
    s_mov_b32 s80, 229376
    buffer_load_dwordx4 v[240:243], v3, s[32:35], s80 offen offset:0 nt
    s_waitcnt vmcnt(7)
    s_cmp_lg_u32 s26, 4
    s_cbranch_scc1 L_wt_skip
    s_mov_b32 s97, 0
L_ml_loop:
    v_cmp_eq_u32 vcc, -1, v148
    v_cmp_eq_u32 s[98:99], -1, v149
    s_or_b64 vcc, vcc, s[98:99]
    s_cmp_eq_u64 vcc, 0
    s_nop 2
    s_cbranch_scc1 L_ml_ok
    s_add_u32 s97, s97, 1
    s_cmp_gt_u32 s97, 200000
    s_cbranch_scc1 L_ml_ok
    s_mov_b64 exec, vcc
    v_and_b32 v6, 7, v1
    v_lshlrev_b32 v6, 11, v6
    buffer_load_dwordx2 v[148:149], v6, s[64:67], 0 offen offset:1280 sc1
    s_mov_b64 exec, -1
    s_waitcnt vmcnt(0)
    s_branch L_ml_loop
L_ml_ok:
    v_max_f32_dpp v17, v148, v148 quad_perm:[1,0,3,2] row_mask:0xf bank_mask:0xf
    s_nop 1
    v_max_f32_dpp v17, v17, v17 quad_perm:[2,3,0,1] row_mask:0xf bank_mask:0xf
    s_nop 1
    v_max_f32_dpp v17, v17, v17 row_half_mirror row_mask:0xf bank_mask:0xf
    v_sub_f32 v17, v148, v17
    v_mul_f32 v17, 0x3fb8aa3b, v17
    v_exp_f32 v17, v17
    s_nop 0
    v_mul_f32 v18, v17, v149
    s_nop 1
    v_add_f32_dpp v18, v18, v18 quad_perm:[1,0,3,2] row_mask:0xf bank_mask:0xf
    s_nop 1
    v_add_f32_dpp v18, v18, v18 quad_perm:[2,3,0,1] row_mask:0xf bank_mask:0xf
    s_nop 1
    v_add_f32_dpp v18, v18, v18 row_half_mirror row_mask:0xf bank_mask:0xf
    v_rcp_f32 v19, v18
    s_nop 0
    v_mul_f32 v16, v17, v19
    v_and_b32 v6, 7, v1
    v_lshlrev_b32 v6, 2, v6
    ds_write_b32 v6, v16 offset:10240
    s_waitcnt lgkmcnt(0)
L_wt_skip:
    s_lshl_b32 s81, s3, 2
    v_mov_b32 v6, s81
    s_barrier
    ds_read_b32 v16, v6 offset:10240
    s_waitcnt lgkmcnt(0)
    v_mul_f32 v32, v32, v16
    v_mul_f32 v33, v33, v16
    v_mul_f32 v34, v34, v16
    v_mul_f32 v35, v35, v16
    v_mul_f32 v36, v36, v16
    v_mul_f32 v37, v37, v16
    v_mul_f32 v38, v38, v16
    v_mul_f32 v39, v39, v16
    v_cvt_pk_bf16_f32 v32, v32, v32
    v_cvt_pk_bf16_f32 v33, v33, v33
    v_cvt_pk_bf16_f32 v34, v34, v34
    v_cvt_pk_bf16_f32 v35, v35, v35
    v_cvt_pk_bf16_f32 v36, v36, v36
    v_cvt_pk_bf16_f32 v37, v37, v37
    v_cvt_pk_bf16_f32 v38, v38, v38
    v_cvt_pk_bf16_f32 v39, v39, v39
    v_lshlrev_b32 v2, 4, v1
    v_add_u32 v2, s95, v2
    ds_read_b128 v[40:43], v2 offset:0
    ds_read_b128 v[44:47], v2 offset:1024
    ds_read_b128 v[184:187], v2 offset:2048
    ds_read_b128 v[188:191], v2 offset:3072
    v_and_b32_dpp v48, v32, v8 row_newbcast:0 row_mask:0xf bank_mask:0xf
    v_and_b32_dpp v49, v32, v9 row_newbcast:0 row_mask:0xf bank_mask:0xf
    v_and_b32_dpp v50, v32, v10 row_newbcast:0 row_mask:0xf bank_mask:0xf
    v_and_b32_dpp v51, v32, v11 row_newbcast:0 row_mask:0xf bank_mask:0xf
    s_waitcnt lgkmcnt(3)
    s_nop 0
    v_mfma_f32_16x16x32_bf16 v[56:59], v[40:43], v[48:51], 0
    v_and_b32_dpp v52, v32, v8 row_newbcast:4 row_mask:0xf bank_mask:0xf
    v_and_b32_dpp v53, v32, v9 row_newbcast:4 row_mask:0xf bank_mask:0xf
    v_and_b32_dpp v54, v32, v10 row_newbcast:4 row_mask:0xf bank_mask:0xf
    v_and_b32_dpp v55, v32, v11 row_newbcast:4 row_mask:0xf bank_mask:0xf
    s_waitcnt lgkmcnt(2)
    s_nop 0
    v_mfma_f32_16x16x32_bf16 v[56:59], v[44:47], v[52:55], v[56:59]
    v_and_b32_dpp v48, v32, v8 row_newbcast:8 row_mask:0xf bank_mask:0xf
    v_and_b32_dpp v49, v32, v9 row_newbcast:8 row_mask:0xf bank_mask:0xf
    v_and_b32_dpp v50, v32, v10 row_newbcast:8 row_mask:0xf bank_mask:0xf
    v_and_b32_dpp v51, v32, v11 row_newbcast:8 row_mask:0xf bank_mask:0xf
    s_waitcnt lgkmcnt(1)
    s_nop 0
    v_mfma_f32_16x16x32_bf16 v[56:59], v[184:187], v[48:51], v[56:59]
    v_and_b32_dpp v52, v32, v8 row_newbcast:12 row_mask:0xf bank_mask:0xf
    v_and_b32_dpp v53, v32, v9 row_newbcast:12 row_mask:0xf bank_mask:0xf
    v_and_b32_dpp v54, v32, v10 row_newbcast:12 row_mask:0xf bank_mask:0xf
    v_and_b32_dpp v55, v32, v11 row_newbcast:12 row_mask:0xf bank_mask:0xf
    s_waitcnt lgkmcnt(0)
    s_nop 0
    v_mfma_f32_16x16x32_bf16 v[56:59], v[188:191], v[52:55], v[56:59]
    ds_read_b128 v[40:43], v2 offset:4096
    ds_read_b128 v[44:47], v2 offset:5120
    ds_read_b128 v[184:187], v2 offset:6144
    ds_read_b128 v[188:191], v2 offset:7168
    v_and_b32_dpp v48, v33, v8 row_newbcast:0 row_mask:0xf bank_mask:0xf
    v_and_b32_dpp v49, v33, v9 row_newbcast:0 row_mask:0xf bank_mask:0xf
    v_and_b32_dpp v50, v33, v10 row_newbcast:0 row_mask:0xf bank_mask:0xf
    v_and_b32_dpp v51, v33, v11 row_newbcast:0 row_mask:0xf bank_mask:0xf
    s_waitcnt lgkmcnt(3)
    s_nop 0
    v_mfma_f32_16x16x32_bf16 v[56:59], v[40:43], v[48:51], v[56:59]
    v_and_b32_dpp v52, v33, v8 row_newbcast:4 row_mask:0xf bank_mask:0xf
    v_and_b32_dpp v53, v33, v9 row_newbcast:4 row_mask:0xf bank_mask:0xf
    v_and_b32_dpp v54, v33, v10 row_newbcast:4 row_mask:0xf bank_mask:0xf
    v_and_b32_dpp v55, v33, v11 row_newbcast:4 row_mask:0xf bank_mask:0xf
    s_waitcnt lgkmcnt(2)
    s_nop 0
    v_mfma_f32_16x16x32_bf16 v[56:59], v[44:47], v[52:55], v[56:59]
    v_and_b32_dpp v48, v33, v8 row_newbcast:8 row_mask:0xf bank_mask:0xf
    v_and_b32_dpp v49, v33, v9 row_newbcast:8 row_mask:0xf bank_mask:0xf
    v_and_b32_dpp v50, v33, v10 row_newbcast:8 row_mask:0xf bank_mask:0xf
    v_and_b32_dpp v51, v33, v11 row_newbcast:8 row_mask:0xf bank_mask:0xf
    s_waitcnt lgkmcnt(1)
    s_nop 0
    v_mfma_f32_16x16x32_bf16 v[56:59], v[184:187], v[48:51], v[56:59]
    v_and_b32_dpp v52, v33, v8 row_newbcast:12 row_mask:0xf bank_mask:0xf
    v_and_b32_dpp v53, v33, v9 row_newbcast:12 row_mask:0xf bank_mask:0xf
    v_and_b32_dpp v54, v33, v10 row_newbcast:12 row_mask:0xf bank_mask:0xf
    v_and_b32_dpp v55, v33, v11 row_newbcast:12 row_mask:0xf bank_mask:0xf
    s_waitcnt lgkmcnt(0)
    s_nop 0
    v_mfma_f32_16x16x32_bf16 v[56:59], v[188:191], v[52:55], v[56:59]
    s_mov_b32 s80, 229376
    buffer_load_dwordx4 v[244:247], v3, s[32:35], s80 offen offset:1024 nt
    ds_read_b128 v[40:43], v2 offset:8192
    ds_read_b128 v[44:47], v2 offset:9216
    ds_read_b128 v[184:187], v2 offset:10240
    ds_read_b128 v[188:191], v2 offset:11264
    v_and_b32_dpp v48, v34, v8 row_newbcast:0 row_mask:0xf bank_mask:0xf
    v_and_b32_dpp v49, v34, v9 row_newbcast:0 row_mask:0xf bank_mask:0xf
    v_and_b32_dpp v50, v34, v10 row_newbcast:0 row_mask:0xf bank_mask:0xf
    v_and_b32_dpp v51, v34, v11 row_newbcast:0 row_mask:0xf bank_mask:0xf
    s_waitcnt lgkmcnt(3)
    s_nop 0
    v_mfma_f32_16x16x32_bf16 v[56:59], v[40:43], v[48:51], v[56:59]
    v_and_b32_dpp v52, v34, v8 row_newbcast:4 row_mask:0xf bank_mask:0xf
    v_and_b32_dpp v53, v34, v9 row_newbcast:4 row_mask:0xf bank_mask:0xf
    v_and_b32_dpp v54, v34, v10 row_newbcast:4 row_mask:0xf bank_mask:0xf
    v_and_b32_dpp v55, v34, v11 row_newbcast:4 row_mask:0xf bank_mask:0xf
    s_waitcnt lgkmcnt(2)
    s_nop 0
    v_mfma_f32_16x16x32_bf16 v[56:59], v[44:47], v[52:55], v[56:59]
    v_and_b32_dpp v48, v34, v8 row_newbcast:8 row_mask:0xf bank_mask:0xf
    v_and_b32_dpp v49, v34, v9 row_newbcast:8 row_mask:0xf bank_mask:0xf
    v_and_b32_dpp v50, v34, v10 row_newbcast:8 row_mask:0xf bank_mask:0xf
    v_and_b32_dpp v51, v34, v11 row_newbcast:8 row_mask:0xf bank_mask:0xf
    s_waitcnt lgkmcnt(1)
    s_nop 0
    v_mfma_f32_16x16x32_bf16 v[56:59], v[184:187], v[48:51], v[56:59]
    v_and_b32_dpp v52, v34, v8 row_newbcast:12 row_mask:0xf bank_mask:0xf
    v_and_b32_dpp v53, v34, v9 row_newbcast:12 row_mask:0xf bank_mask:0xf
    v_and_b32_dpp v54, v34, v10 row_newbcast:12 row_mask:0xf bank_mask:0xf
    v_and_b32_dpp v55, v34, v11 row_newbcast:12 row_mask:0xf bank_mask:0xf
    s_waitcnt lgkmcnt(0)
    s_nop 0
    v_mfma_f32_16x16x32_bf16 v[56:59], v[188:191], v[52:55], v[56:59]
    s_waitcnt vmcnt(7)
    s_mov_b32 s80, 229376
    buffer_load_dwordx4 v[248:251], v3, s[32:35], s80 offen offset:2048 nt
    s_waitcnt vmcnt(7)
    s_mov_b32 s80, 229376
    buffer_load_dwordx4 v[252:255], v3, s[32:35], s80 offen offset:3072 nt
    ds_read_b128 v[40:43], v2 offset:12288
    ds_read_b128 v[44:47], v2 offset:13312
    ds_read_b128 v[184:187], v2 offset:14336
    ds_read_b128 v[188:191], v2 offset:15360
    v_and_b32_dpp v48, v35, v8 row_newbcast:0 row_mask:0xf bank_mask:0xf
    v_and_b32_dpp v49, v35, v9 row_newbcast:0 row_mask:0xf bank_mask:0xf
    v_and_b32_dpp v50, v35, v10 row_newbcast:0 row_mask:0xf bank_mask:0xf
    v_and_b32_dpp v51, v35, v11 row_newbcast:0 row_mask:0xf bank_mask:0xf
    s_waitcnt lgkmcnt(3)
    s_nop 0
    v_mfma_f32_16x16x32_bf16 v[56:59], v[40:43], v[48:51], v[56:59]
    v_and_b32_dpp v52, v35, v8 row_newbcast:4 row_mask:0xf bank_mask:0xf
    v_and_b32_dpp v53, v35, v9 row_newbcast:4 row_mask:0xf bank_mask:0xf
    v_and_b32_dpp v54, v35, v10 row_newbcast:4 row_mask:0xf bank_mask:0xf
    v_and_b32_dpp v55, v35, v11 row_newbcast:4 row_mask:0xf bank_mask:0xf
    s_waitcnt lgkmcnt(2)
    s_nop 0
    v_mfma_f32_16x16x32_bf16 v[56:59], v[44:47], v[52:55], v[56:59]
    v_and_b32_dpp v48, v35, v8 row_newbcast:8 row_mask:0xf bank_mask:0xf
    v_and_b32_dpp v49, v35, v9 row_newbcast:8 row_mask:0xf bank_mask:0xf
    v_and_b32_dpp v50, v35, v10 row_newbcast:8 row_mask:0xf bank_mask:0xf
    v_and_b32_dpp v51, v35, v11 row_newbcast:8 row_mask:0xf bank_mask:0xf
    s_waitcnt lgkmcnt(1)
    s_nop 0
    v_mfma_f32_16x16x32_bf16 v[56:59], v[184:187], v[48:51], v[56:59]
    v_and_b32_dpp v52, v35, v8 row_newbcast:12 row_mask:0xf bank_mask:0xf
    v_and_b32_dpp v53, v35, v9 row_newbcast:12 row_mask:0xf bank_mask:0xf
    v_and_b32_dpp v54, v35, v10 row_newbcast:12 row_mask:0xf bank_mask:0xf
    v_and_b32_dpp v55, v35, v11 row_newbcast:12 row_mask:0xf bank_mask:0xf
    s_waitcnt lgkmcnt(0)
    s_nop 0
    v_mfma_f32_16x16x32_bf16 v[56:59], v[188:191], v[52:55], v[56:59]
    s_waitcnt vmcnt(7)
    s_barrier
    s_mov_b32 s80, 0
    buffer_load_dwordx4 v[128:131], v4, s[40:43], s80 offen nt
    s_waitcnt vmcnt(7)
    s_mov_b32 s80, 8192
    buffer_load_dwordx4 v[132:135], v4, s[40:43], s80 offen nt
    v_and_b32_dpp v48, v36, v8 row_newbcast:0 row_mask:0xf bank_mask:0xf
    v_and_b32_dpp v49, v36, v9 row_newbcast:0 row_mask:0xf bank_mask:0xf
    v_and_b32_dpp v50, v36, v10 row_newbcast:0 row_mask:0xf bank_mask:0xf
    v_and_b32_dpp v51, v36, v11 row_newbcast:0 row_mask:0xf bank_mask:0xf
    s_nop 1
    v_mfma_f32_16x16x32_bf16 v[56:59], v[192:195], v[48:51], v[56:59]
    v_and_b32_dpp v52, v36, v8 row_newbcast:4 row_mask:0xf bank_mask:0xf
    v_and_b32_dpp v53, v36, v9 row_newbcast:4 row_mask:0xf bank_mask:0xf
    v_and_b32_dpp v54, v36, v10 row_newbcast:4 row_mask:0xf bank_mask:0xf
    v_and_b32_dpp v55, v36, v11 row_newbcast:4 row_mask:0xf bank_mask:0xf
    s_nop 1
    v_mfma_f32_16x16x32_bf16 v[56:59], v[196:199], v[52:55], v[56:59]
    v_and_b32_dpp v48, v36, v8 row_newbcast:8 row_mask:0xf bank_mask:0xf
    v_and_b32_dpp v49, v36, v9 row_newbcast:8 row_mask:0xf bank_mask:0xf
    v_and_b32_dpp v50, v36, v10 row_newbcast:8 row_mask:0xf bank_mask:0xf
    v_and_b32_dpp v51, v36, v11 row_newbcast:8 row_mask:0xf bank_mask:0xf
    s_nop 1
    v_mfma_f32_16x16x32_bf16 v[56:59], v[200:203], v[48:51], v[56:59]
    v_and_b32_dpp v52, v36, v8 row_newbcast:12 row_mask:0xf bank_mask:0xf
    v_and_b32_dpp v53, v36, v9 row_newbcast:12 row_mask:0xf bank_mask:0xf
    v_and_b32_dpp v54, v36, v10 row_newbcast:12 row_mask:0xf bank_mask:0xf
    v_and_b32_dpp v55, v36, v11 row_newbcast:12 row_mask:0xf bank_mask:0xf
    s_nop 1
    v_mfma_f32_16x16x32_bf16 v[56:59], v[204:207], v[52:55], v[56:59]
    v_and_b32_dpp v48, v37, v8 row_newbcast:0 row_mask:0xf bank_mask:0xf
    v_and_b32_dpp v49, v37, v9 row_newbcast:0 row_mask:0xf bank_mask:0xf
    v_and_b32_dpp v50, v37, v10 row_newbcast:0 row_mask:0xf bank_mask:0xf
    v_and_b32_dpp v51, v37, v11 row_newbcast:0 row_mask:0xf bank_mask:0xf
    s_nop 1
    v_mfma_f32_16x16x32_bf16 v[56:59], v[208:211], v[48:51], v[56:59]
    v_and_b32_dpp v52, v37, v8 row_newbcast:4 row_mask:0xf bank_mask:0xf
    v_and_b32_dpp v53, v37, v9 row_newbcast:4 row_mask:0xf bank_mask:0xf
    v_and_b32_dpp v54, v37, v10 row_newbcast:4 row_mask:0xf bank_mask:0xf
    v_and_b32_dpp v55, v37, v11 row_newbcast:4 row_mask:0xf bank_mask:0xf
    s_nop 1
    v_mfma_f32_16x16x32_bf16 v[56:59], v[212:215], v[52:55], v[56:59]
    v_and_b32_dpp v48, v37, v8 row_newbcast:8 row_mask:0xf bank_mask:0xf
    v_and_b32_dpp v49, v37, v9 row_newbcast:8 row_mask:0xf bank_mask:0xf
    v_and_b32_dpp v50, v37, v10 row_newbcast:8 row_mask:0xf bank_mask:0xf
    v_and_b32_dpp v51, v37, v11 row_newbcast:8 row_mask:0xf bank_mask:0xf
    s_nop 1
    v_mfma_f32_16x16x32_bf16 v[56:59], v[216:219], v[48:51], v[56:59]
    v_and_b32_dpp v52, v37, v8 row_newbcast:12 row_mask:0xf bank_mask:0xf
    v_and_b32_dpp v53, v37, v9 row_newbcast:12 row_mask:0xf bank_mask:0xf
    v_and_b32_dpp v54, v37, v10 row_newbcast:12 row_mask:0xf bank_mask:0xf
    v_and_b32_dpp v55, v37, v11 row_newbcast:12 row_mask:0xf bank_mask:0xf
    s_nop 1
    v_mfma_f32_16x16x32_bf16 v[56:59], v[220:223], v[52:55], v[56:59]
    v_and_b32_dpp v48, v38, v8 row_newbcast:0 row_mask:0xf bank_mask:0xf
    v_and_b32_dpp v49, v38, v9 row_newbcast:0 row_mask:0xf bank_mask:0xf
    v_and_b32_dpp v50, v38, v10 row_newbcast:0 row_mask:0xf bank_mask:0xf
    v_and_b32_dpp v51, v38, v11 row_newbcast:0 row_mask:0xf bank_mask:0xf
    s_nop 1
    v_mfma_f32_16x16x32_bf16 v[56:59], v[224:227], v[48:51], v[56:59]
    v_and_b32_dpp v52, v38, v8 row_newbcast:4 row_mask:0xf bank_mask:0xf
    v_and_b32_dpp v53, v38, v9 row_newbcast:4 row_mask:0xf bank_mask:0xf
    v_and_b32_dpp v54, v38, v10 row_newbcast:4 row_mask:0xf bank_mask:0xf
    v_and_b32_dpp v55, v38, v11 row_newbcast:4 row_mask:0xf bank_mask:0xf
    s_nop 1
    v_mfma_f32_16x16x32_bf16 v[56:59], v[228:231], v[52:55], v[56:59]
    s_waitcnt vmcnt(7)
    v_and_b32_dpp v48, v38, v8 row_newbcast:8 row_mask:0xf bank_mask:0xf
    v_and_b32_dpp v49, v38, v9 row_newbcast:8 row_mask:0xf bank_mask:0xf
    v_and_b32_dpp v50, v38, v10 row_newbcast:8 row_mask:0xf bank_mask:0xf
    v_and_b32_dpp v51, v38, v11 row_newbcast:8 row_mask:0xf bank_mask:0xf
    s_nop 1
    v_mfma_f32_16x16x32_bf16 v[56:59], v[232:235], v[48:51], v[56:59]
    s_waitcnt vmcnt(6)
    v_and_b32_dpp v52, v38, v8 row_newbcast:12 row_mask:0xf bank_mask:0xf
    v_and_b32_dpp v53, v38, v9 row_newbcast:12 row_mask:0xf bank_mask:0xf
    v_and_b32_dpp v54, v38, v10 row_newbcast:12 row_mask:0xf bank_mask:0xf
    v_and_b32_dpp v55, v38, v11 row_newbcast:12 row_mask:0xf bank_mask:0xf
    s_nop 1
    v_mfma_f32_16x16x32_bf16 v[56:59], v[236:239], v[52:55], v[56:59]
    s_waitcnt vmcnt(5)
    v_and_b32_dpp v48, v39, v8 row_newbcast:0 row_mask:0xf bank_mask:0xf
    v_and_b32_dpp v49, v39, v9 row_newbcast:0 row_mask:0xf bank_mask:0xf
    v_and_b32_dpp v50, v39, v10 row_newbcast:0 row_mask:0xf bank_mask:0xf
    v_and_b32_dpp v51, v39, v11 row_newbcast:0 row_mask:0xf bank_mask:0xf
    s_nop 1
    v_mfma_f32_16x16x32_bf16 v[56:59], v[240:243], v[48:51], v[56:59]
    s_waitcnt vmcnt(4)
    v_and_b32_dpp v52, v39, v8 row_newbcast:4 row_mask:0xf bank_mask:0xf
    v_and_b32_dpp v53, v39, v9 row_newbcast:4 row_mask:0xf bank_mask:0xf
    v_and_b32_dpp v54, v39, v10 row_newbcast:4 row_mask:0xf bank_mask:0xf
    v_and_b32_dpp v55, v39, v11 row_newbcast:4 row_mask:0xf bank_mask:0xf
    s_nop 1
    v_mfma_f32_16x16x32_bf16 v[56:59], v[244:247], v[52:55], v[56:59]
    s_waitcnt vmcnt(3)
    v_and_b32_dpp v48, v39, v8 row_newbcast:8 row_mask:0xf bank_mask:0xf
    v_and_b32_dpp v49, v39, v9 row_newbcast:8 row_mask:0xf bank_mask:0xf
    v_and_b32_dpp v50, v39, v10 row_newbcast:8 row_mask:0xf bank_mask:0xf
    v_and_b32_dpp v51, v39, v11 row_newbcast:8 row_mask:0xf bank_mask:0xf
    s_nop 1
    v_mfma_f32_16x16x32_bf16 v[56:59], v[248:251], v[48:51], v[56:59]
    s_waitcnt vmcnt(2)
    v_and_b32_dpp v52, v39, v8 row_newbcast:12 row_mask:0xf bank_mask:0xf
    v_and_b32_dpp v53, v39, v9 row_newbcast:12 row_mask:0xf bank_mask:0xf
    v_and_b32_dpp v54, v39, v10 row_newbcast:12 row_mask:0xf bank_mask:0xf
    v_and_b32_dpp v55, v39, v11 row_newbcast:12 row_mask:0xf bank_mask:0xf
    s_nop 1
    v_mfma_f32_16x16x32_bf16 v[56:59], v[252:255], v[52:55], v[56:59]
    s_nop 7
L_tail:
    v_lshrrev_b32 v6, 4, v1
    v_lshlrev_b32 v6, 7, v6
    v_and_b32 v7, 15, v1
    v_lshl_add_u32 v6, v7, 2, v6
    s_lshl_b32 s81, s26, 9
    v_add_u32 v6, s81, v6
    s_mov_b32 exec_lo, 0x00ff00ff
    s_mov_b32 exec_hi, 0x00ff00ff
    ds_write_b32 v6, v56 offset:1024
    ds_write_b32 v6, v57 offset:1056
    ds_write_b32 v6, v58 offset:1088
    ds_write_b32 v6, v59 offset:1120
    s_mov_b64 exec, -1
    v_and_b32 v2, 7, v1
    v_lshlrev_b32 v2, 11, v2
    v_bfe_u32 v7, v1, 3, 1
    v_lshl_add_u32 v2, v7, 5, v2
    v_lshrrev_b32 v7, 4, v1
    v_lshl_add_u32 v2, v7, 3, v2
    s_lshl_b32 s80, s26, 6
    v_lshlrev_b32 v6, 3, v1
    s_waitcnt lgkmcnt(0)
    s_barrier
    s_cmp_lg_u32 s26, 0
    s_cbranch_scc1 L_pubo_skip
    ds_read_b64 v[40:41], v6 offset:1024
    ds_read_b64 v[42:43], v6 offset:1536
    ds_read_b64 v[44:45], v6 offset:2048
    ds_read_b64 v[46:47], v6 offset:2560
    ds_read_b64 v[48:49], v6 offset:3072
    ds_read_b64 v[50:51], v6 offset:3584
    ds_read_b64 v[52:53], v6 offset:4096
    ds_read_b64 v[54:55], v6 offset:4608
    s_waitcnt lgkmcnt(0)
    v_pk_add_f32 v[40:41], v[40:41], v[42:43]
    v_pk_add_f32 v[44:45], v[44:45], v[46:47]
    v_pk_add_f32 v[48:49], v[48:49], v[50:51]
    v_pk_add_f32 v[52:53], v[52:53], v[54:55]
    v_pk_add_f32 v[40:41], v[40:41], v[44:45]
    v_pk_add_f32 v[48:49], v[48:49], v[52:53]
    v_pk_add_f32 v[40:41], v[40:41], v[48:49]
    v_min_u32 v40, -2, v40
    v_min_u32 v41, -2, v41
    buffer_store_dwordx2 v[40:41], v6, s[56:59], 0 offen offset:512 sc1
    s_nop 0
L_pubo_skip:
    buffer_load_dwordx2 v[152:153], v2, s[64:67], s80 offen offset:512 sc1
    s_waitcnt vmcnt(0)
    s_mov_b32 s97, 0
L_op_loop:
    v_cmp_eq_u32 vcc, -1, v152
    v_cmp_eq_u32 s[98:99], -1, v153
    s_or_b64 vcc, vcc, s[98:99]
    s_cmp_eq_u64 vcc, 0
    s_nop 2
    s_cbranch_scc1 L_op_ok
    s_add_u32 s97, s97, 1
    s_cmp_gt_u32 s97, 200000
    s_cbranch_scc1 L_op_ok
    s_mov_b64 exec, vcc
    buffer_load_dwordx2 v[152:153], v2, s[64:67], s80 offen offset:512 sc1
    s_mov_b64 exec, -1
    s_waitcnt vmcnt(0)
    s_branch L_op_loop
L_op_ok:
    v_add_f32_dpp v152, v152, v152 quad_perm:[1,0,3,2] row_mask:0xf bank_mask:0xf
    v_add_f32_dpp v153, v153, v153 quad_perm:[1,0,3,2] row_mask:0xf bank_mask:0xf
    s_nop 0
    v_add_f32_dpp v152, v152, v152 quad_perm:[2,3,0,1] row_mask:0xf bank_mask:0xf
    v_add_f32_dpp v153, v153, v153 quad_perm:[2,3,0,1] row_mask:0xf bank_mask:0xf
    s_nop 0
    v_add_f32_dpp v152, v152, v152 row_half_mirror row_mask:0xf bank_mask:0xf
    v_add_f32_dpp v153, v153, v153 row_half_mirror row_mask:0xf bank_mask:0xf
    v_cvt_pk_bf16_f32 v60, v152, v153
    s_nop 1
    v_mov_b32_dpp v32, v60 row_newbcast:0 row_mask:0xf bank_mask:0xf
    v_perm_b32 v48, v32, v32, v12
    v_perm_b32 v49, v32, v32, v13
    v_perm_b32 v50, v32, v32, v14
    v_perm_b32 v51, v32, v32, v15
    v_mov_b32_dpp v33, v60 row_newbcast:8 row_mask:0xf bank_mask:0xf
    v_perm_b32 v52, v33, v33, v12
    v_perm_b32 v53, v33, v33, v13
    v_perm_b32 v54, v33, v33, v14
    v_perm_b32 v55, v33, v33, v15
    v_mfma_f32_16x16x32_bf16 v[56:59], v[128:131], v[48:51], 0
    s_nop 0
    v_mfma_f32_16x16x32_bf16 v[56:59], v[132:135], v[52:55], v[56:59]
    v_lshrrev_b32 v6, 4, v1
    v_lshlrev_b32 v6, 6, v6
    v_and_b32 v7, 15, v1
    v_lshl_add_u32 v6, v7, 2, v6
    s_lshl_b32 s81, s26, 8
    v_add_u32 v6, s81, v6
    s_nop 1
    v_add_f32_dpp v60, v57, v56 row_ror:8 row_mask:0xf bank_mask:0xf
    v_add_f32_dpp v61, v59, v58 row_ror:8 row_mask:0xf bank_mask:0xf
    s_mov_b32 exec_lo, 0x00ff00ff
    s_mov_b32 exec_hi, 0x00ff00ff
    ds_write_b32 v6, v60 offset:7424
    ds_write_b32 v6, v61 offset:7456
    s_mov_b64 exec, -1
    v_lshlrev_b32 v6, 2, v1
    s_waitcnt lgkmcnt(0)
    s_barrier
    s_cmp_lg_u32 s26, 0
    s_cbranch_scc1 L_puby_skip
    ds_read_b32 v32, v6 offset:7424
    ds_read_b32 v33, v6 offset:7680
    ds_read_b32 v34, v6 offset:7936
    ds_read_b32 v35, v6 offset:8192
    ds_read_b32 v36, v6 offset:8448
    ds_read_b32 v37, v6 offset:8704
    ds_read_b32 v38, v6 offset:8960
    ds_read_b32 v39, v6 offset:9216
    s_waitcnt lgkmcnt(0)
    v_pk_add_f32 v[32:33], v[32:33], v[34:35]
    v_pk_add_f32 v[36:37], v[36:37], v[38:39]
    v_pk_add_f32 v[32:33], v[32:33], v[36:37]
    v_add_f32 v32, v32, v33
    v_min_u32 v32, -2, v32
    buffer_store_dword v32, v6, s[56:59], 0 offen offset:1024 sc1
    s_nop 0
L_puby_skip:
    s_cmp_eq_u32 s83, 0
    s_cbranch_scc1 L_end
    s_mov_b32 s81, s0
    s_lshr_b32 s97, s81, 2
    s_lshl_b32 s97, s97, 11
    s_and_b32 s80, s81, 3
    s_lshl_b32 s80, s80, 6
    s_add_u32 s97, s97, s80
    s_add_u32 s97, s97, 0x400
    s_add_u32 s28, s24, s97
    s_addc_u32 s29, s25, 0
    s_mov_b32 s30, 507968
    s_mov_b32 s31, 0x20000
    v_lshrrev_b32 v2, 2, v1
    v_lshlrev_b32 v2, 14, v2
    v_and_b32 v7, 3, v1
    v_lshl_add_u32 v2, v7, 4, v2
    s_mov_b32 s80, 262144
    s_cmp_eq_u32 s26, 0
    s_cbranch_scc0 L_end
    buffer_load_dwordx4 v[168:171], v2, s[28:31], 0 offen sc1
    buffer_load_dwordx4 v[172:175], v2, s[28:31], s80 offen sc1
    s_mov_b32 s32, s20
    s_mov_b32 s33, s21
    s_mov_b32 s34, 1024
    s_mov_b32 s35, 0x20000
    s_waitcnt vmcnt(0)
    s_mov_b32 s97, 0
L_y_loop:
    v_cmp_eq_u32 vcc, -1, v168
    v_cmp_eq_u32 s[98:99], -1, v169
    s_or_b64 vcc, vcc, s[98:99]
    v_cmp_eq_u32 s[98:99], -1, v170
    s_or_b64 vcc, vcc, s[98:99]
    v_cmp_eq_u32 s[98:99], -1, v171
    s_or_b64 vcc, vcc, s[98:99]
    v_cmp_eq_u32 s[98:99], -1, v172
    s_or_b64 vcc, vcc, s[98:99]
    v_cmp_eq_u32 s[98:99], -1, v173
    s_or_b64 vcc, vcc, s[98:99]
    v_cmp_eq_u32 s[98:99], -1, v174
    s_or_b64 vcc, vcc, s[98:99]
    v_cmp_eq_u32 s[98:99], -1, v175
    s_or_b64 vcc, vcc, s[98:99]
    s_cmp_eq_u64 vcc, 0
    s_nop 2
    s_cbranch_scc1 L_y_ok
    s_add_u32 s97, s97, 1
    s_cmp_gt_u32 s97, 200000
    s_cbranch_scc1 L_y_ok
    s_mov_b64 exec, vcc
    buffer_load_dwordx4 v[168:171], v2, s[28:31], 0 offen sc1
    buffer_load_dwordx4 v[172:175], v2, s[28:31], s80 offen sc1
    s_mov_b64 exec, -1
    s_waitcnt vmcnt(0)
    s_branch L_y_loop
L_y_ok:
    v_add_f32 v168, v168, v172
    v_add_f32 v169, v169, v173
    v_add_f32 v170, v170, v174
    v_add_f32 v171, v171, v175
    s_nop 0
    v_permlane32_swap_b32 v168, v170
    v_permlane32_swap_b32 v169, v171
    v_add_f32 v168, v168, v170
    v_add_f32 v169, v169, v171
    s_nop 1
    v_permlane16_swap_b32 v168, v169
    v_add_f32 v168, v168, v169
    s_nop 1
    v_add_f32_dpp v168, v168, v168 row_ror:8 row_mask:0xf bank_mask:0xf
    s_nop 1
    v_add_f32_dpp v168, v168, v168 row_ror:4 row_mask:0xf bank_mask:0xf
    v_cvt_pk_bf16_f32 v168, v168, v168
    v_and_b32 v168, 0xffff0000, v168
    v_mul_f32 v168, v168, v176
    v_cvt_pk_bf16_f32 v168, v168, v168
    v_and_b32 v168, 0xffff0000, v168
    v_lshlrev_b32 v177, 16, v177
    v_add_f32 v168, v168, v177
    v_cvt_pk_bf16_f32 v168, v168, v168
    s_mov_b32 exec_lo, 0x000f000f
    s_mov_b32 exec_hi, 0x000f000f
    buffer_store_short v168, v179, s[32:35], 0 offen
    s_mov_b64 exec, -1
L_end:
L_exit:
    s_endpgm
.p2align 6
L_code_end:
    s_nop 0
    s_nop 0
    s_nop 0
    s_nop 0
    s_nop 0
    s_nop 0
    s_nop 0
    s_nop 0
    s_nop 0
    s_nop 0
    s_nop 0
    s_nop 0
    s_nop 0
    s_nop 0
    s_nop 0
    s_nop 0
    s_nop 0
    s_nop 0
    s_nop 0
    s_nop 0
    s_nop 0
    s_nop 0
    s_nop 0
    s_nop 0
    s_nop 0
    s_nop 0
    s_nop 0
    s_nop 0
    s_nop 0
    s_nop 0
    s_nop 0
    s_nop 0
    s_nop 0
    s_nop 0
    s_nop 0
    s_nop 0
    s_nop 0
    s_nop 0
    s_nop 0
    s_nop 0
    s_nop 0
    s_nop 0
    s_nop 0
    s_nop 0
    s_nop 0
    s_nop 0
    s_nop 0
    s_nop 0
    s_nop 0
    s_nop 0
    s_nop 0
    s_nop 0
    s_nop 0
    s_nop 0
    s_nop 0
    s_nop 0
    s_nop 0
    s_nop 0
    s_nop 0
    s_nop 0
    s_nop 0
    s_nop 0
    s_nop 0
    s_nop 0
.section .rodata,"a"
.p2align 6
.amdhsa_kernel recurrent_scan__gqa_block_cached__dense_activation_silu__decode_kernel
  .amdhsa_next_free_vgpr 256
  .amdhsa_next_free_sgpr 102
  .amdhsa_accum_offset 256
  .amdhsa_group_segment_fixed_size 0
  .amdhsa_kernarg_size 88
  .amdhsa_user_sgpr_count 2
  .amdhsa_user_sgpr_kernarg_segment_ptr 1
  .amdhsa_system_sgpr_workgroup_id_x 1
  .amdhsa_float_denorm_mode_32 3
  .amdhsa_float_denorm_mode_16_64 3
.end_amdhsa_kernel
```
